```python
import torch

def _softmax(x, axis=-1):
    return torch.softmax(x, dim=axis)
def _gelu(x):
    return torch.nn.functional.gelu(x, approximate="tanh")
def _silu(x):
    return torch.nn.functional.silu(x)
def _sigmoid(x):
    return torch.sigmoid(x)
def _layernorm(x, axis=-1, eps=1e-5):
    m = x.mean(dim=axis, keepdim=True)
    v = x.var(dim=axis, keepdim=True, unbiased=False)
    return (x - m) / torch.sqrt(v + eps)
def _scatter_add(tgt, idx, src, axis=0):
    return tgt.clone().index_add_(axis, idx, src)
def _segment_sum(src, seg, n):
    out = torch.zeros((n,) + src.shape[1:], dtype=src.dtype)
    return out.index_add_(0, seg, src)
def _pad(x, pw):
    flat = tuple(v for pair in reversed(pw) for v in pair)
    return torch.nn.functional.pad(x, flat)

kernel_name = 'concat_heads__mha_block_cached__mha_block_cached__near_ridge'

def setup_inputs():

    _w = (lambda a: (lambda t: t.to(torch.bfloat16) if t.is_floating_point() else t)(torch.as_tensor(a)))
    def _A_setup():
        B, Sq, D = 16, 64, 448
        H, Sk, Dh = 16, 64, 256
        return {
            "x": _w((lambda *s: torch.randn(*s, dtype=torch.bfloat16) * 0.8)(B, Sq, D)),
            "k_cache": _w((lambda *s: torch.randn(*s, dtype=torch.bfloat16) * 0.8)(B, H, Sk, Dh)),
            "v_cache": _w((lambda *s: torch.randn(*s, dtype=torch.bfloat16) * 0.05)(B, H, Sk, Dh)),
            "wq": _w((lambda *s: torch.randn(*s, dtype=torch.bfloat16) * 0.8)(D, H * Dh) * (D ** -0.5)),
            "wo": _w((lambda *s: torch.randn(*s, dtype=torch.bfloat16) * 0.05)(H * Dh, D) * ((H * Dh) ** -0.5)),
        }
    _A_in = _A_setup()

    def _B_setup():
        B, Sq, D = 16, 64, 448
        H, Sk, Dh = 16, 64, 256
        return {
            "x": _w((lambda *s: torch.randn(*s, dtype=torch.bfloat16) * 0.8)(B, Sq, D)),
            "k_cache": _w((lambda *s: torch.randn(*s, dtype=torch.bfloat16) * 0.8)(B, H, Sk, Dh)),
            "v_cache": _w((lambda *s: torch.randn(*s, dtype=torch.bfloat16) * 0.05)(B, H, Sk, Dh)),
            "wq": _w((lambda *s: torch.randn(*s, dtype=torch.bfloat16) * 0.8)(D, H * Dh) * (D ** -0.5)),
            "wo": _w((lambda *s: torch.randn(*s, dtype=torch.bfloat16) * 0.05)(H * Dh, D) * ((H * Dh) ** -0.5)),
        }
    _B_in = _B_setup()

    return {
        "A_x": _A_in["x"],
        "A_k_cache": _A_in["k_cache"],
        "A_v_cache": _A_in["v_cache"],
        "A_wq": _A_in["wq"],
        "A_wo": _A_in["wo"],
        "B_x": _B_in["x"],
        "B_k_cache": _B_in["k_cache"],
        "B_v_cache": _B_in["v_cache"],
        "B_wq": _B_in["wq"],
        "B_wo": _B_in["wo"],
    }

def reference(A_x, A_k_cache, A_v_cache, A_wq, A_wo, B_x, B_k_cache, B_v_cache, B_wq, B_wo):
    def _A_ref(x, k_cache, v_cache, wq, wo):
        B, Sq, D = x.shape
        H, Dh = 16, 256
        q = (lambda x, *d: x.permute(*d))((x @ wq).reshape(B, Sq, H, Dh), 0, 2, 1, 3)
        scores = torch.einsum("bhqd,bhkd->bhqk", q, k_cache) * (Dh ** -0.5)
        p = _softmax(scores, axis=-1)
        o = torch.einsum("bhqk,bhkd->bhqd", p, v_cache)
        return (lambda x, *d: x.permute(*d))(o, 0, 2, 1, 3).reshape(B, Sq, H * Dh) @ wo

    def _B_ref(x, k_cache, v_cache, wq, wo):
        B, Sq, D = x.shape
        H, Dh = 16, 256
        q = (lambda x, *d: x.permute(*d))((x @ wq).reshape(B, Sq, H, Dh), 0, 2, 1, 3)
        scores = torch.einsum("bhqd,bhkd->bhqk", q, k_cache) * (Dh ** -0.5)
        p = _softmax(scores, axis=-1)
        o = torch.einsum("bhqk,bhkd->bhqd", p, v_cache)
        return (lambda x, *d: x.permute(*d))(o, 0, 2, 1, 3).reshape(B, Sq, H * Dh) @ wo

    a = _A_ref(A_x, A_k_cache, A_v_cache, A_wq, A_wo)
    b = _B_ref(B_x, B_k_cache, B_v_cache, B_wq, B_wo)
    return torch.concatenate([a, b], axis=-1)
```

```asm
; @launch grid=(256,1,1) block=(512,1,1) lds=163840
.amdgcn_target "amdgcn-amd-amdhsa--gfx950"
.text
.globl concat_heads__mha_block_cached__mha_block_cached__near_ridge_kernel
.p2align 8
.type concat_heads__mha_block_cached__mha_block_cached__near_ridge_kernel,@function
concat_heads__mha_block_cached__mha_block_cached__near_ridge_kernel:
s_cmp_ge_u32 s2, 256
s_cbranch_scc1 L_main_end
s_and_b32 s3, s2, 7
s_lshr_b32 s4, s2, 3
s_lshr_b32 s5, s3, 2
s_mul_i32 s6, s5, 40
s_load_dwordx2 s[18:19], s[0:1], 96
s_load_dwordx4 s[84:87], s[0:1], 80
s_add_u32 s0, s0, s6
s_addc_u32 s1, s1, 0
s_load_dwordx8 s[8:15], s[0:1], 0
s_load_dwordx2 s[16:17], s[0:1], 32
s_and_b32 s6, s3, 3
s_lshl_b32 s6, s6, 2
s_and_b32 s7, s4, 3
s_add_u32 s6, s6, s7
s_lshr_b32 s7, s4, 2
v_lshrrev_b32 v1, 6, v0
v_and_b32 v0, 63, v0
s_nop 0
v_readfirstlane_b32 s44, v1
s_cmp_lt_u32 s44, 4
s_cbranch_scc1 L_compute
s_sub_u32 s61, s44, 4
s_and_b32 s44, s61, 3
s_lshl_b32 s45, s44, 10
v_lshrrev_b32 v1, 3, v0
v_and_b32 v2, 7, v0
v_lshrrev_b32 v3, 4, v0
s_and_b32 s46, s44, 1
s_lshl_b32 s47, s46, 2
v_add_u32 v4, s47, v3
v_and_b32 v4, 7, v4
v_xor_b32 v4, v4, v2
s_lshl_b32 s47, s44, 3
v_add_u32 v1, s47, v1
v_mul_u32_u24 v1, 896, v1
v_lshl_add_u32 v10, v4, 4, v1
v_lshrrev_b32 v16, 5, v0
v_and_b32 v17, 31, v0
s_lshl_b32 s47, s44, 1
v_add_u32 v16, s47, v16
v_and_b32 v18, 3, v16
v_lshlrev_b32 v18, 2, v18
v_xor_b32 v18, v18, v17
v_lshlrev_b32 v18, 4, v18
v_lshl_add_u32 v11, v16, 13, v18
s_mul_i32 s48, s7, 114688
s_lshl_b32 s49, s6, 9
s_waitcnt lgkmcnt(0)
s_mov_b32 s20, s8
s_and_b32 s21, s9, 0xffff
s_mov_b32 s22, 917504
s_mov_b32 s23, 0x20000
s_mov_b32 s32, s14
s_and_b32 s33, s15, 0xffff
s_mov_b32 s34, 3670016
s_mov_b32 s35, 0x20000
s_mov_b32 s57, s48
s_add_u32 s52, s57, 0
s_add_u32 m0, s45, 65536
s_nop 0
buffer_load_dwordx4 v10, s[20:23], s52 offen  lds
s_add_u32 s52, s57, 28672
s_add_u32 m0, s45, 69632
s_nop 0
buffer_load_dwordx4 v10, s[20:23], s52 offen  lds
s_add_u32 s52, s57, 57344
s_add_u32 m0, s45, 73728
s_nop 0
buffer_load_dwordx4 v10, s[20:23], s52 offen  lds
s_add_u32 s52, s57, 86016
s_add_u32 m0, s45, 77824
s_nop 0
buffer_load_dwordx4 v10, s[20:23], s52 offen  lds
s_mov_b32 s58, s49
s_add_u32 s52, s58, 0
s_add_u32 m0, s45, 0
s_nop 0
buffer_load_dwordx4 v11, s[32:35], s52 offen  lds
s_add_u32 s52, s58, 65536
s_add_u32 m0, s45, 4096
s_nop 0
buffer_load_dwordx4 v11, s[32:35], s52 offen  lds
s_add_u32 s52, s58, 131072
s_add_u32 m0, s45, 8192
s_nop 0
buffer_load_dwordx4 v11, s[32:35], s52 offen  lds
s_add_u32 s52, s58, 196608
s_add_u32 m0, s45, 12288
s_nop 0
buffer_load_dwordx4 v11, s[32:35], s52 offen  lds
s_add_u32 s52, s58, 262144
s_add_u32 m0, s45, 16384
s_nop 0
buffer_load_dwordx4 v11, s[32:35], s52 offen  lds
s_add_u32 s52, s58, 327680
s_add_u32 m0, s45, 20480
s_nop 0
buffer_load_dwordx4 v11, s[32:35], s52 offen  lds
s_add_u32 s52, s58, 393216
s_add_u32 m0, s45, 24576
s_nop 0
buffer_load_dwordx4 v11, s[32:35], s52 offen  lds
s_add_u32 s52, s58, 458752
s_add_u32 m0, s45, 28672
s_nop 0
buffer_load_dwordx4 v11, s[32:35], s52 offen  lds
s_and_b32 s55, s4, 3
s_lshl_b32 s55, s55, 1
s_add_u32 s55, s55, s7
s_cmp_ge_u32 s55, 6
s_cselect_b32 s60, 6, 0
s_sub_u32 s55, s55, s60
s_cmp_ge_u32 s55, 6
s_cselect_b32 s60, 6, 0
s_sub_u32 s55, s55, s60
s_add_u32 s55, s55, 1
s_mov_b32 s60, s55
s_cmp_ge_u32 s7, 7
s_cselect_b32 s56, 0, s7
s_lshl_b32 s81, s5, 3
s_add_u32 s81, s81, s7
s_mov_b32 s79, s56
v_and_b32 v4, 1, v3
v_lshlrev_b32 v4, 2, v4
v_xor_b32 v4, v4, v2
v_lshl_add_u32 v12, v4, 4, v1
v_lshl_add_u32 v15, v16, 9, v18
v_xor_b32 v3, v16, v17
v_lshlrev_b32 v3, 4, v3
v_lshl_add_u32 v4, v16, 9, v3
v_xor_b32 v6, 128, v4
s_lshl_b32 s50, s7, 5
s_add_u32 s50, s50, s6
s_lshl_b32 s50, s50, 15
s_mul_i32 s51, s6, 229376
s_add_u32 s47, s4, s3
s_lshr_b32 s53, s4, 3
s_add_u32 s47, s47, s53
s_and_b32 s47, s47, 7
s_lshl_b32 s47, s47, 12
s_or_b32 s50, s50, s47
s_and_b32 s46, s47, 0x3000
s_or_b32 s46, s46, s45
s_and_b32 s47, s47, 0x1000
s_lshr_b32 s47, s47, 5
v_xor_b32 v4, s47, v4
v_xor_b32 v6, s47, v6
s_mul_i32 s57, s55, 128
s_add_u32 s57, s57, s48
s_add_u32 s55, s55, 1
s_cmp_eq_u32 s55, 7
s_cselect_b32 s55, 1, s55
s_add_u32 s52, s57, 0
s_add_u32 m0, s45, 81920
s_nop 0
buffer_load_dwordx4 v10, s[20:23], s52 offen  lds
s_add_u32 s52, s57, 28672
s_add_u32 m0, s45, 86016
s_nop 0
buffer_load_dwordx4 v10, s[20:23], s52 offen  lds
s_add_u32 s52, s57, 57344
s_add_u32 m0, s45, 90112
s_nop 0
buffer_load_dwordx4 v10, s[20:23], s52 offen  lds
s_add_u32 s52, s57, 86016
s_add_u32 m0, s45, 94208
s_nop 0
buffer_load_dwordx4 v10, s[20:23], s52 offen  lds
s_mul_i32 s58, s60, 524288
s_add_u32 s58, s58, s49
s_add_u32 s60, s60, 1
s_cmp_eq_u32 s60, 7
s_cselect_b32 s60, 1, s60
s_add_u32 s52, s58, 0
s_add_u32 m0, s45, 32768
s_nop 0
buffer_load_dwordx4 v11, s[32:35], s52 offen  lds
s_add_u32 s52, s58, 65536
s_add_u32 m0, s45, 36864
s_nop 0
buffer_load_dwordx4 v11, s[32:35], s52 offen  lds
s_add_u32 s52, s58, 131072
s_add_u32 m0, s45, 40960
s_nop 0
buffer_load_dwordx4 v11, s[32:35], s52 offen  lds
s_add_u32 s52, s58, 196608
s_add_u32 m0, s45, 45056
s_nop 0
buffer_load_dwordx4 v11, s[32:35], s52 offen  lds
s_add_u32 s52, s58, 262144
s_add_u32 m0, s45, 49152
s_nop 0
buffer_load_dwordx4 v11, s[32:35], s52 offen  lds
s_add_u32 s52, s58, 327680
s_add_u32 m0, s45, 53248
s_nop 0
buffer_load_dwordx4 v11, s[32:35], s52 offen  lds
s_add_u32 s52, s58, 393216
s_add_u32 m0, s45, 57344
s_nop 0
buffer_load_dwordx4 v11, s[32:35], s52 offen  lds
s_add_u32 s52, s58, 458752
s_add_u32 m0, s45, 61440
s_nop 0
buffer_load_dwordx4 v11, s[32:35], s52 offen  lds
s_mov_b32 s24, s10
s_and_b32 s25, s11, 0xffff
s_mov_b32 s26, 8388608
s_mov_b32 s27, 0x20000
s_mov_b32 s28, s12
s_and_b32 s29, s13, 0xffff
s_mov_b32 s30, 8388608
s_mov_b32 s31, 0x20000
s_mov_b32 s36, s16
s_and_b32 s37, s17, 0xffff
s_mov_b32 s38, 3670016
s_mov_b32 s39, 0x20000
s_mov_b32 s40, s18
s_and_b32 s41, s19, 0xffff
s_mov_b32 s42, 268435456
s_mov_b32 s43, 0x20000
s_mov_b32 s88, s86
s_and_b32 s89, s87, 0xffff
s_mov_b32 s90, 256
s_mov_b32 s91, 0x20000
s_mov_b32 s92, s84
s_and_b32 s93, s85, 0xffff
s_mov_b32 s94, 1835008
s_mov_b32 s95, 0x20000
s_waitcnt vmcnt(16)
s_barrier
s_xor_b32 s52, s50, 0
s_xor_b32 m0, s46, 98304
s_nop 0
buffer_load_dwordx4 v4, s[24:27], s52 offen nt lds
s_waitcnt vmcnt(13)
s_barrier
s_mul_i32 s58, s60, 524288
s_add_u32 s58, s58, s49
s_add_u32 s60, s60, 1
s_cmp_eq_u32 s60, 7
s_cselect_b32 s60, 1, s60
s_add_u32 s52, s58, 0
s_add_u32 m0, s45, 0
s_nop 0
buffer_load_dwordx4 v11, s[32:35], s52 offen  lds
s_add_u32 s52, s58, 65536
s_add_u32 m0, s45, 4096
s_nop 0
buffer_load_dwordx4 v11, s[32:35], s52 offen  lds
s_add_u32 s52, s58, 131072
s_add_u32 m0, s45, 8192
s_nop 0
buffer_load_dwordx4 v11, s[32:35], s52 offen  lds
s_add_u32 s52, s58, 196608
s_add_u32 m0, s45, 12288
s_nop 0
buffer_load_dwordx4 v11, s[32:35], s52 offen  lds
s_xor_b32 s52, s50, 4096
s_xor_b32 m0, s46, 102400
s_nop 0
buffer_load_dwordx4 v6, s[24:27], s52 offen nt lds
s_xor_b32 s52, s50, 8192
s_xor_b32 m0, s46, 106496
s_nop 0
buffer_load_dwordx4 v4, s[24:27], s52 offen nt lds
s_waitcnt vmcnt(11)
s_barrier
s_add_u32 s52, s58, 262144
s_add_u32 m0, s45, 16384
s_nop 0
buffer_load_dwordx4 v11, s[32:35], s52 offen  lds
s_add_u32 s52, s58, 327680
s_add_u32 m0, s45, 20480
s_nop 0
buffer_load_dwordx4 v11, s[32:35], s52 offen  lds
s_add_u32 s52, s58, 393216
s_add_u32 m0, s45, 24576
s_nop 0
buffer_load_dwordx4 v11, s[32:35], s52 offen  lds
s_add_u32 s52, s58, 458752
s_add_u32 m0, s45, 28672
s_nop 0
buffer_load_dwordx4 v11, s[32:35], s52 offen  lds
s_mul_i32 s57, s55, 128
s_add_u32 s57, s57, s48
s_add_u32 s55, s55, 1
s_cmp_eq_u32 s55, 7
s_cselect_b32 s55, 1, s55
s_add_u32 s52, s57, 0
s_add_u32 m0, s45, 65536
s_nop 0
buffer_load_dwordx4 v10, s[20:23], s52 offen  lds
s_add_u32 s52, s57, 28672
s_add_u32 m0, s45, 69632
s_nop 0
buffer_load_dwordx4 v10, s[20:23], s52 offen  lds
s_add_u32 s52, s57, 57344
s_add_u32 m0, s45, 73728
s_nop 0
buffer_load_dwordx4 v10, s[20:23], s52 offen  lds
s_add_u32 s52, s57, 86016
s_add_u32 m0, s45, 77824
s_nop 0
buffer_load_dwordx4 v10, s[20:23], s52 offen  lds
s_xor_b32 s52, s50, 12288
s_xor_b32 m0, s46, 110592
s_nop 0
buffer_load_dwordx4 v6, s[24:27], s52 offen nt lds
s_xor_b32 s52, s50, 524288
s_xor_b32 m0, s46, 114688
s_nop 0
buffer_load_dwordx4 v4, s[24:27], s52 offen nt lds
s_waitcnt vmcnt(17)
s_barrier
s_mul_i32 s58, s60, 524288
s_add_u32 s58, s58, s49
s_add_u32 s60, s60, 1
s_cmp_eq_u32 s60, 7
s_cselect_b32 s60, 1, s60
s_add_u32 s52, s58, 0
s_add_u32 m0, s45, 32768
s_nop 0
buffer_load_dwordx4 v11, s[32:35], s52 offen  lds
s_add_u32 s52, s58, 65536
s_add_u32 m0, s45, 36864
s_nop 0
buffer_load_dwordx4 v11, s[32:35], s52 offen  lds
s_add_u32 s52, s58, 131072
s_add_u32 m0, s45, 40960
s_nop 0
buffer_load_dwordx4 v11, s[32:35], s52 offen  lds
s_add_u32 s52, s58, 196608
s_add_u32 m0, s45, 45056
s_nop 0
buffer_load_dwordx4 v11, s[32:35], s52 offen  lds
s_xor_b32 s52, s50, 528384
s_xor_b32 m0, s46, 118784
s_nop 0
buffer_load_dwordx4 v6, s[24:27], s52 offen nt lds
s_xor_b32 s52, s50, 532480
s_xor_b32 m0, s46, 122880
s_nop 0
buffer_load_dwordx4 v4, s[24:27], s52 offen nt lds
s_waitcnt vmcnt(8)
s_barrier
s_add_u32 s52, s58, 262144
s_add_u32 m0, s45, 49152
s_nop 0
buffer_load_dwordx4 v11, s[32:35], s52 offen  lds
s_add_u32 s52, s58, 327680
s_add_u32 m0, s45, 53248
s_nop 0
buffer_load_dwordx4 v11, s[32:35], s52 offen  lds
s_add_u32 s52, s58, 393216
s_add_u32 m0, s45, 57344
s_nop 0
buffer_load_dwordx4 v11, s[32:35], s52 offen  lds
s_add_u32 s52, s58, 458752
s_add_u32 m0, s45, 61440
s_nop 0
buffer_load_dwordx4 v11, s[32:35], s52 offen  lds
s_mul_i32 s57, s55, 128
s_add_u32 s57, s57, s48
s_add_u32 s55, s55, 1
s_cmp_eq_u32 s55, 7
s_cselect_b32 s55, 1, s55
s_add_u32 s52, s57, 0
s_add_u32 m0, s45, 81920
s_nop 0
buffer_load_dwordx4 v10, s[20:23], s52 offen  lds
s_add_u32 s52, s57, 28672
s_add_u32 m0, s45, 86016
s_nop 0
buffer_load_dwordx4 v10, s[20:23], s52 offen  lds
s_add_u32 s52, s57, 57344
s_add_u32 m0, s45, 90112
s_nop 0
buffer_load_dwordx4 v10, s[20:23], s52 offen  lds
s_add_u32 s52, s57, 86016
s_add_u32 m0, s45, 94208
s_nop 0
buffer_load_dwordx4 v10, s[20:23], s52 offen  lds
s_xor_b32 s52, s50, 536576
s_xor_b32 m0, s46, 126976
s_nop 0
buffer_load_dwordx4 v6, s[24:27], s52 offen nt lds
s_xor_b32 s52, s50, 0
s_xor_b32 m0, s46, 131072
s_nop 0
buffer_load_dwordx4 v15, s[28:31], s52 offen nt lds
s_waitcnt vmcnt(18)
s_barrier
s_mul_i32 s58, s60, 524288
s_add_u32 s58, s58, s49
s_add_u32 s60, s60, 1
s_cmp_eq_u32 s60, 7
s_cselect_b32 s60, 1, s60
s_add_u32 s52, s58, 0
s_add_u32 m0, s45, 0
s_nop 0
buffer_load_dwordx4 v11, s[32:35], s52 offen  lds
s_add_u32 s52, s58, 65536
s_add_u32 m0, s45, 4096
s_nop 0
buffer_load_dwordx4 v11, s[32:35], s52 offen  lds
s_add_u32 s52, s58, 131072
s_add_u32 m0, s45, 8192
s_nop 0
buffer_load_dwordx4 v11, s[32:35], s52 offen  lds
s_add_u32 s52, s58, 196608
s_add_u32 m0, s45, 12288
s_nop 0
buffer_load_dwordx4 v11, s[32:35], s52 offen  lds
s_xor_b32 s52, s50, 4096
s_xor_b32 m0, s46, 135168
s_nop 0
buffer_load_dwordx4 v15, s[28:31], s52 offen nt lds
s_xor_b32 s52, s50, 8192
s_xor_b32 m0, s46, 139264
s_nop 0
buffer_load_dwordx4 v15, s[28:31], s52 offen nt lds
s_waitcnt vmcnt(8)
s_barrier
s_add_u32 s52, s58, 262144
s_add_u32 m0, s45, 16384
s_nop 0
buffer_load_dwordx4 v11, s[32:35], s52 offen  lds
s_add_u32 s52, s58, 327680
s_add_u32 m0, s45, 20480
s_nop 0
buffer_load_dwordx4 v11, s[32:35], s52 offen  lds
s_add_u32 s52, s58, 393216
s_add_u32 m0, s45, 24576
s_nop 0
buffer_load_dwordx4 v11, s[32:35], s52 offen  lds
s_add_u32 s52, s58, 458752
s_add_u32 m0, s45, 28672
s_nop 0
buffer_load_dwordx4 v11, s[32:35], s52 offen  lds
s_mul_i32 s57, s55, 128
s_add_u32 s57, s57, s48
s_add_u32 s55, s55, 1
s_cmp_eq_u32 s55, 7
s_cselect_b32 s55, 1, s55
s_add_u32 s52, s57, 0
s_add_u32 m0, s45, 65536
s_nop 0
buffer_load_dwordx4 v10, s[20:23], s52 offen  lds
s_add_u32 s52, s57, 28672
s_add_u32 m0, s45, 69632
s_nop 0
buffer_load_dwordx4 v10, s[20:23], s52 offen  lds
s_add_u32 s52, s57, 57344
s_add_u32 m0, s45, 73728
s_nop 0
buffer_load_dwordx4 v10, s[20:23], s52 offen  lds
s_add_u32 s52, s57, 86016
s_add_u32 m0, s45, 77824
s_nop 0
buffer_load_dwordx4 v10, s[20:23], s52 offen  lds
s_xor_b32 s52, s50, 12288
s_xor_b32 m0, s46, 143360
s_nop 0
buffer_load_dwordx4 v15, s[28:31], s52 offen nt lds
s_xor_b32 s52, s50, 524288
s_xor_b32 m0, s46, 147456
s_nop 0
buffer_load_dwordx4 v15, s[28:31], s52 offen nt lds
s_waitcnt vmcnt(18)
s_barrier
s_mul_i32 s58, s60, 524288
s_add_u32 s58, s58, s49
s_add_u32 s60, s60, 1
s_cmp_eq_u32 s60, 7
s_cselect_b32 s60, 1, s60
s_add_u32 s52, s58, 0
s_add_u32 m0, s45, 32768
s_nop 0
buffer_load_dwordx4 v11, s[32:35], s52 offen  lds
s_add_u32 s52, s58, 65536
s_add_u32 m0, s45, 36864
s_nop 0
buffer_load_dwordx4 v11, s[32:35], s52 offen  lds
s_add_u32 s52, s58, 131072
s_add_u32 m0, s45, 40960
s_nop 0
buffer_load_dwordx4 v11, s[32:35], s52 offen  lds
s_add_u32 s52, s58, 196608
s_add_u32 m0, s45, 45056
s_nop 0
buffer_load_dwordx4 v11, s[32:35], s52 offen  lds
s_xor_b32 s52, s50, 528384
s_xor_b32 m0, s46, 151552
s_nop 0
buffer_load_dwordx4 v15, s[28:31], s52 offen nt lds
s_xor_b32 s52, s50, 532480
s_xor_b32 m0, s46, 155648
s_nop 0
buffer_load_dwordx4 v15, s[28:31], s52 offen nt lds
s_waitcnt vmcnt(8)
s_barrier
s_add_u32 s52, s58, 262144
s_add_u32 m0, s45, 49152
s_nop 0
buffer_load_dwordx4 v11, s[32:35], s52 offen  lds
s_add_u32 s52, s58, 327680
s_add_u32 m0, s45, 53248
s_nop 0
buffer_load_dwordx4 v11, s[32:35], s52 offen  lds
s_add_u32 s52, s58, 393216
s_add_u32 m0, s45, 57344
s_nop 0
buffer_load_dwordx4 v11, s[32:35], s52 offen  lds
s_add_u32 s52, s58, 458752
s_add_u32 m0, s45, 61440
s_nop 0
buffer_load_dwordx4 v11, s[32:35], s52 offen  lds
s_mul_i32 s57, s55, 128
s_add_u32 s57, s57, s48
s_add_u32 s55, s55, 1
s_cmp_eq_u32 s55, 7
s_cselect_b32 s55, 1, s55
s_add_u32 s52, s57, 0
s_add_u32 m0, s45, 81920
s_nop 0
buffer_load_dwordx4 v10, s[20:23], s52 offen  lds
s_add_u32 s52, s57, 28672
s_add_u32 m0, s45, 86016
s_nop 0
buffer_load_dwordx4 v10, s[20:23], s52 offen  lds
s_add_u32 s52, s57, 57344
s_add_u32 m0, s45, 90112
s_nop 0
buffer_load_dwordx4 v10, s[20:23], s52 offen  lds
s_add_u32 s52, s57, 86016
s_add_u32 m0, s45, 94208
s_nop 0
buffer_load_dwordx4 v10, s[20:23], s52 offen  lds
s_xor_b32 s52, s50, 536576
s_xor_b32 m0, s46, 159744
s_nop 0
buffer_load_dwordx4 v15, s[28:31], s52 offen nt lds
s_waitcnt vmcnt(17)
s_barrier
s_mul_i32 s58, s60, 524288
s_add_u32 s58, s58, s49
s_add_u32 s60, s60, 1
s_cmp_eq_u32 s60, 7
s_cselect_b32 s60, 1, s60
s_add_u32 s52, s58, 0
s_add_u32 m0, s45, 0
s_nop 0
buffer_load_dwordx4 v11, s[32:35], s52 offen  lds
s_add_u32 s52, s58, 65536
s_add_u32 m0, s45, 4096
s_nop 0
buffer_load_dwordx4 v11, s[32:35], s52 offen  lds
s_add_u32 s52, s58, 131072
s_add_u32 m0, s45, 8192
s_nop 0
buffer_load_dwordx4 v11, s[32:35], s52 offen  lds
s_add_u32 s52, s58, 196608
s_add_u32 m0, s45, 12288
s_nop 0
buffer_load_dwordx4 v11, s[32:35], s52 offen  lds
s_waitcnt vmcnt(5)
s_barrier
s_add_u32 s52, s58, 262144
s_add_u32 m0, s45, 16384
s_nop 0
buffer_load_dwordx4 v11, s[32:35], s52 offen  lds
s_add_u32 s52, s58, 327680
s_add_u32 m0, s45, 20480
s_nop 0
buffer_load_dwordx4 v11, s[32:35], s52 offen  lds
s_add_u32 s52, s58, 393216
s_add_u32 m0, s45, 24576
s_nop 0
buffer_load_dwordx4 v11, s[32:35], s52 offen  lds
s_add_u32 s52, s58, 458752
s_add_u32 m0, s45, 28672
s_nop 0
buffer_load_dwordx4 v11, s[32:35], s52 offen  lds
s_mul_i32 s57, s55, 128
s_add_u32 s57, s57, s48
s_add_u32 s55, s55, 1
s_cmp_eq_u32 s55, 7
s_cselect_b32 s55, 1, s55
s_add_u32 s52, s57, 0
s_add_u32 m0, s45, 65536
s_nop 0
buffer_load_dwordx4 v10, s[20:23], s52 offen  lds
s_add_u32 s52, s57, 28672
s_add_u32 m0, s45, 69632
s_nop 0
buffer_load_dwordx4 v10, s[20:23], s52 offen  lds
s_add_u32 s52, s57, 57344
s_add_u32 m0, s45, 73728
s_nop 0
buffer_load_dwordx4 v10, s[20:23], s52 offen  lds
s_add_u32 s52, s57, 86016
s_add_u32 m0, s45, 77824
s_nop 0
buffer_load_dwordx4 v10, s[20:23], s52 offen  lds
s_waitcnt vmcnt(13)
s_barrier
s_xor_b32 s52, s50, 16384
s_xor_b32 m0, s46, 32768
s_nop 0
buffer_load_dwordx4 v4, s[24:27], s52 offen nt lds
s_xor_b32 s52, s50, 20480
s_xor_b32 m0, s46, 36864
s_nop 0
buffer_load_dwordx4 v6, s[24:27], s52 offen nt lds
s_xor_b32 s52, s50, 24576
s_xor_b32 m0, s46, 40960
s_nop 0
buffer_load_dwordx4 v4, s[24:27], s52 offen nt lds
s_xor_b32 s52, s50, 28672
s_xor_b32 m0, s46, 45056
s_nop 0
buffer_load_dwordx4 v6, s[24:27], s52 offen nt lds
s_waitcnt vmcnt(4)
s_barrier
s_xor_b32 s52, s50, 540672
s_xor_b32 m0, s46, 49152
s_nop 0
buffer_load_dwordx4 v4, s[24:27], s52 offen nt lds
s_xor_b32 s52, s50, 544768
s_xor_b32 m0, s46, 53248
s_nop 0
buffer_load_dwordx4 v6, s[24:27], s52 offen nt lds
s_xor_b32 s52, s50, 548864
s_xor_b32 m0, s46, 57344
s_nop 0
buffer_load_dwordx4 v4, s[24:27], s52 offen nt lds
s_xor_b32 s52, s50, 552960
s_xor_b32 m0, s46, 61440
s_nop 0
buffer_load_dwordx4 v6, s[24:27], s52 offen nt lds
s_xor_b32 s52, s50, 16384
s_xor_b32 m0, s46, 81920
s_nop 0
buffer_load_dwordx4 v15, s[28:31], s52 offen nt lds
s_xor_b32 s52, s50, 20480
s_xor_b32 m0, s46, 86016
s_nop 0
buffer_load_dwordx4 v15, s[28:31], s52 offen nt lds
s_xor_b32 s52, s50, 24576
s_xor_b32 m0, s46, 90112
s_nop 0
buffer_load_dwordx4 v15, s[28:31], s52 offen nt lds
s_xor_b32 s52, s50, 28672
s_xor_b32 m0, s46, 94208
s_nop 0
buffer_load_dwordx4 v15, s[28:31], s52 offen nt lds
s_waitcnt vmcnt(12)
s_barrier
s_xor_b32 s52, s50, 540672
s_xor_b32 m0, s46, 0
s_nop 0
buffer_load_dwordx4 v15, s[28:31], s52 offen nt lds
s_xor_b32 s52, s50, 544768
s_xor_b32 m0, s46, 4096
s_nop 0
buffer_load_dwordx4 v15, s[28:31], s52 offen nt lds
s_xor_b32 s52, s50, 548864
s_xor_b32 m0, s46, 8192
s_nop 0
buffer_load_dwordx4 v15, s[28:31], s52 offen nt lds
s_xor_b32 s52, s50, 552960
s_xor_b32 m0, s46, 12288
s_nop 0
buffer_load_dwordx4 v15, s[28:31], s52 offen nt lds
s_waitcnt vmcnt(60)
s_barrier
s_mul_i32 s59, s56, 128
s_add_u32 s59, s59, s51
s_add_u32 s56, s56, 1
s_cmp_eq_u32 s56, 7
s_cselect_b32 s56, 0, s56
s_add_u32 s52, s59, 0
s_add_u32 m0, s45, 16384
s_nop 0
buffer_load_dwordx4 v12, s[36:39], s52 offen  lds
s_add_u32 s52, s59, 28672
s_add_u32 m0, s45, 20480
s_nop 0
buffer_load_dwordx4 v12, s[36:39], s52 offen  lds
s_add_u32 s52, s59, 57344
s_add_u32 m0, s45, 24576
s_nop 0
buffer_load_dwordx4 v12, s[36:39], s52 offen  lds
s_add_u32 s52, s59, 86016
s_add_u32 m0, s45, 28672
s_nop 0
buffer_load_dwordx4 v12, s[36:39], s52 offen  lds
s_add_u32 s52, s59, 114688
s_add_u32 m0, s45, 65536
s_nop 0
buffer_load_dwordx4 v12, s[36:39], s52 offen  lds
s_add_u32 s52, s59, 143360
s_add_u32 m0, s45, 69632
s_nop 0
buffer_load_dwordx4 v12, s[36:39], s52 offen  lds
s_add_u32 s52, s59, 172032
s_add_u32 m0, s45, 73728
s_nop 0
buffer_load_dwordx4 v12, s[36:39], s52 offen  lds
s_add_u32 s52, s59, 200704
s_add_u32 m0, s45, 77824
s_nop 0
buffer_load_dwordx4 v12, s[36:39], s52 offen  lds
s_waitcnt vmcnt(16)
s_barrier
s_waitcnt vmcnt(36)
s_barrier
s_mul_i32 s59, s56, 128
s_add_u32 s59, s59, s51
s_add_u32 s56, s56, 1
s_cmp_eq_u32 s56, 7
s_cselect_b32 s56, 0, s56
s_add_u32 s52, s59, 0
s_add_u32 m0, s45, 98304
s_nop 0
buffer_load_dwordx4 v12, s[36:39], s52 offen  lds
s_add_u32 s52, s59, 28672
s_add_u32 m0, s45, 102400
s_nop 0
buffer_load_dwordx4 v12, s[36:39], s52 offen  lds
s_add_u32 s52, s59, 57344
s_add_u32 m0, s45, 106496
s_nop 0
buffer_load_dwordx4 v12, s[36:39], s52 offen  lds
s_add_u32 s52, s59, 86016
s_add_u32 m0, s45, 110592
s_nop 0
buffer_load_dwordx4 v12, s[36:39], s52 offen  lds
s_add_u32 s52, s59, 114688
s_add_u32 m0, s45, 114688
s_nop 0
buffer_load_dwordx4 v12, s[36:39], s52 offen  lds
s_add_u32 s52, s59, 143360
s_add_u32 m0, s45, 118784
s_nop 0
buffer_load_dwordx4 v12, s[36:39], s52 offen  lds
s_add_u32 s52, s59, 172032
s_add_u32 m0, s45, 122880
s_nop 0
buffer_load_dwordx4 v12, s[36:39], s52 offen  lds
s_add_u32 s52, s59, 200704
s_add_u32 m0, s45, 126976
s_nop 0
buffer_load_dwordx4 v12, s[36:39], s52 offen  lds
s_mul_i32 s59, s56, 128
s_add_u32 s59, s59, s51
s_add_u32 s56, s56, 1
s_cmp_eq_u32 s56, 7
s_cselect_b32 s56, 0, s56
s_add_u32 s52, s59, 0
s_add_u32 m0, s45, 32768
s_nop 0
buffer_load_dwordx4 v12, s[36:39], s52 offen  lds
s_add_u32 s52, s59, 28672
s_add_u32 m0, s45, 36864
s_nop 0
buffer_load_dwordx4 v12, s[36:39], s52 offen  lds
s_add_u32 s52, s59, 57344
s_add_u32 m0, s45, 40960
s_nop 0
buffer_load_dwordx4 v12, s[36:39], s52 offen  lds
s_add_u32 s52, s59, 86016
s_add_u32 m0, s45, 45056
s_nop 0
buffer_load_dwordx4 v12, s[36:39], s52 offen  lds
s_add_u32 s52, s59, 114688
s_add_u32 m0, s45, 49152
s_nop 0
buffer_load_dwordx4 v12, s[36:39], s52 offen  lds
s_add_u32 s52, s59, 143360
s_add_u32 m0, s45, 53248
s_nop 0
buffer_load_dwordx4 v12, s[36:39], s52 offen  lds
s_add_u32 s52, s59, 172032
s_add_u32 m0, s45, 57344
s_nop 0
buffer_load_dwordx4 v12, s[36:39], s52 offen  lds
s_add_u32 s52, s59, 200704
s_add_u32 m0, s45, 61440
s_nop 0
buffer_load_dwordx4 v12, s[36:39], s52 offen  lds
s_waitcnt vmcnt(24)
s_barrier
s_mul_i32 s59, s56, 128
s_add_u32 s59, s59, s51
s_add_u32 s56, s56, 1
s_cmp_eq_u32 s56, 7
s_cselect_b32 s56, 0, s56
s_add_u32 s52, s59, 0
s_add_u32 m0, s45, 131072
s_nop 0
buffer_load_dwordx4 v12, s[36:39], s52 offen  lds
s_add_u32 s52, s59, 28672
s_add_u32 m0, s45, 135168
s_nop 0
buffer_load_dwordx4 v12, s[36:39], s52 offen  lds
s_add_u32 s52, s59, 57344
s_add_u32 m0, s45, 139264
s_nop 0
buffer_load_dwordx4 v12, s[36:39], s52 offen  lds
s_add_u32 s52, s59, 86016
s_add_u32 m0, s45, 143360
s_nop 0
buffer_load_dwordx4 v12, s[36:39], s52 offen  lds
s_add_u32 s52, s59, 114688
s_add_u32 m0, s45, 147456
s_nop 0
buffer_load_dwordx4 v12, s[36:39], s52 offen  lds
s_add_u32 s52, s59, 143360
s_add_u32 m0, s45, 151552
s_nop 0
buffer_load_dwordx4 v12, s[36:39], s52 offen  lds
s_add_u32 s52, s59, 172032
s_add_u32 m0, s45, 155648
s_nop 0
buffer_load_dwordx4 v12, s[36:39], s52 offen  lds
s_add_u32 s52, s59, 200704
s_add_u32 m0, s45, 159744
s_nop 0
buffer_load_dwordx4 v12, s[36:39], s52 offen  lds
s_waitcnt vmcnt(24)
s_barrier
s_mul_i32 s59, s56, 128
s_add_u32 s59, s59, s51
s_add_u32 s56, s56, 1
s_cmp_eq_u32 s56, 7
s_cselect_b32 s56, 0, s56
s_add_u32 s52, s59, 0
s_add_u32 m0, s45, 81920
s_nop 0
buffer_load_dwordx4 v12, s[36:39], s52 offen  lds
s_add_u32 s52, s59, 28672
s_add_u32 m0, s45, 86016
s_nop 0
buffer_load_dwordx4 v12, s[36:39], s52 offen  lds
s_add_u32 s52, s59, 57344
s_add_u32 m0, s45, 90112
s_nop 0
buffer_load_dwordx4 v12, s[36:39], s52 offen  lds
s_add_u32 s52, s59, 86016
s_add_u32 m0, s45, 94208
s_nop 0
buffer_load_dwordx4 v12, s[36:39], s52 offen  lds
s_add_u32 s52, s59, 114688
s_add_u32 m0, s45, 0
s_nop 0
buffer_load_dwordx4 v12, s[36:39], s52 offen  lds
s_add_u32 s52, s59, 143360
s_add_u32 m0, s45, 4096
s_nop 0
buffer_load_dwordx4 v12, s[36:39], s52 offen  lds
s_add_u32 s52, s59, 172032
s_add_u32 m0, s45, 8192
s_nop 0
buffer_load_dwordx4 v12, s[36:39], s52 offen  lds
s_add_u32 s52, s59, 200704
s_add_u32 m0, s45, 12288
s_nop 0
buffer_load_dwordx4 v12, s[36:39], s52 offen  lds
s_waitcnt vmcnt(24)
s_barrier
v_and_b32 v1, 15, v0
s_lshl_b32 s47, s81, 4
buffer_load_ubyte v10, v1, s[88:91], s47 offen sc1
s_mul_i32 s59, s56, 128
s_add_u32 s59, s59, s51
s_add_u32 s56, s56, 1
s_cmp_eq_u32 s56, 7
s_cselect_b32 s56, 0, s56
s_add_u32 s52, s59, 0
s_add_u32 m0, s45, 16384
s_nop 0
buffer_load_dwordx4 v12, s[36:39], s52 offen  lds
s_add_u32 s52, s59, 28672
s_add_u32 m0, s45, 20480
s_nop 0
buffer_load_dwordx4 v12, s[36:39], s52 offen  lds
s_add_u32 s52, s59, 57344
s_add_u32 m0, s45, 24576
s_nop 0
buffer_load_dwordx4 v12, s[36:39], s52 offen  lds
s_add_u32 s52, s59, 86016
s_add_u32 m0, s45, 28672
s_nop 0
buffer_load_dwordx4 v12, s[36:39], s52 offen  lds
s_add_u32 s52, s59, 114688
s_add_u32 m0, s45, 65536
s_nop 0
buffer_load_dwordx4 v12, s[36:39], s52 offen  lds
s_add_u32 s52, s59, 143360
s_add_u32 m0, s45, 69632
s_nop 0
buffer_load_dwordx4 v12, s[36:39], s52 offen  lds
s_add_u32 s52, s59, 172032
s_add_u32 m0, s45, 73728
s_nop 0
buffer_load_dwordx4 v12, s[36:39], s52 offen  lds
s_add_u32 s52, s59, 200704
s_add_u32 m0, s45, 77824
s_nop 0
buffer_load_dwordx4 v12, s[36:39], s52 offen  lds
s_waitcnt vmcnt(25)
s_barrier
s_mul_i32 s59, s56, 128
s_add_u32 s59, s59, s51
s_add_u32 s56, s56, 1
s_cmp_eq_u32 s56, 7
s_cselect_b32 s56, 0, s56
s_add_u32 s52, s59, 0
s_add_u32 m0, s45, 98304
s_nop 0
buffer_load_dwordx4 v12, s[36:39], s52 offen  lds
s_add_u32 s52, s59, 28672
s_add_u32 m0, s45, 102400
s_nop 0
buffer_load_dwordx4 v12, s[36:39], s52 offen  lds
s_add_u32 s52, s59, 57344
s_add_u32 m0, s45, 106496
s_nop 0
buffer_load_dwordx4 v12, s[36:39], s52 offen  lds
s_add_u32 s52, s59, 86016
s_add_u32 m0, s45, 110592
s_nop 0
buffer_load_dwordx4 v12, s[36:39], s52 offen  lds
s_add_u32 s52, s59, 114688
s_add_u32 m0, s45, 114688
s_nop 0
buffer_load_dwordx4 v12, s[36:39], s52 offen  lds
s_add_u32 s52, s59, 143360
s_add_u32 m0, s45, 118784
s_nop 0
buffer_load_dwordx4 v12, s[36:39], s52 offen  lds
s_add_u32 s52, s59, 172032
s_add_u32 m0, s45, 122880
s_nop 0
buffer_load_dwordx4 v12, s[36:39], s52 offen  lds
s_add_u32 s52, s59, 200704
s_add_u32 m0, s45, 126976
s_nop 0
buffer_load_dwordx4 v12, s[36:39], s52 offen  lds
s_waitcnt vmcnt(25)
s_barrier
s_waitcnt vmcnt(17)
s_barrier
s_waitcnt vmcnt(8)
s_barrier
s_waitcnt vmcnt(0)
s_barrier
s_mov_b32 s59, 0
s_cmp_lt_u32 s61, 2
s_cselect_b32 s59, 2, 0
s_cbranch_scc1 L_nob
s_barrier
L_nob:
s_lshr_b32 s82, s6, 2
s_and_b32 s46, s6, 3
s_lshl_b32 s47, s61, 2
s_add_u32 s46, s46, s47
s_lshl_b32 s80, 1, s46
s_and_b32 s80, s80, 0xfffffff
s_mov_b32 s83, 1
L_red:
v_and_b32 v1, 15, v0
v_lshlrev_b32 v2, 2, v1
v_lshrrev_b32 v3, 3, v0
v_and_b32 v4, 7, v0
v_lshlrev_b32 v5, 9, v3
v_lshl_add_u32 v5, v4, 4, v5
v_mul_u32_u24 v6, 1792, v4
v_lshl_add_u32 v6, v3, 4, v6
v_lshlrev_b32 v5, 4, v0
v_and_b32 v4, 31, v0
v_mul_u32_u24 v6, 1792, v4
v_lshrrev_b32 v3, 5, v0
v_lshl_add_u32 v6, v3, 4, v6
v_bfrev_b32 v7, 1
v_cmp_eq_u32 vcc, 0, v0
s_nop 3
v_cndmask_b32 v7, v7, v0, vcc
s_lshl_b32 s45, s81, 4
L_item:
s_cmp_eq_u32 s80, 0
s_cbranch_scc1 L_fin
s_ff1_i32_b32 s46, s80
s_bitset0_b32 s80, s46
s_lshr_b32 s47, s46, 2
s_mul_i32 s48, s81, 7
s_add_u32 s48, s48, s47
s_lshl_b32 s48, s48, 2
s_add_u32 s48, s48, s82
s_lshl_b32 s48, s48, 7
s_add_u32 s48, s48, 33554432
s_mul_i32 s49, s83, 30000
s_mov_b32 s50, s83
L_poll:
buffer_load_dword v8, v2, s[40:43], s48 offen sc1
v_cmp_ne_u32 s[52:53], 0, v10
s_nop 3
s_cmp_eq_u64 s[52:53], -1
s_cbranch_scc1 L_ht
buffer_load_ubyte v10, v1, s[88:91], s45 offen sc1
L_ht:
s_waitcnt vmcnt(0)
v_cmp_eq_u32 vcc, v8, v10
v_cmp_ne_u32 s[52:53], 0, v10
s_nop 3
s_and_b64 vcc, vcc, s[52:53]
s_cmp_eq_u64 vcc, -1
s_cbranch_scc1 L_go
s_sub_u32 s49, s49, 1
s_cbranch_scc0 L_poll
s_cmp_eq_u32 s50, 0
s_cbranch_scc1 L_item
v_readlane_b32 s51, v10, s6
s_lshl_b32 s52, s81, 2
s_add_u32 s52, s52, s82
s_lshl_b32 s52, s52, 7
s_lshl_b32 s53, s46, 2
s_add_u32 s52, s52, s53
s_add_u32 s52, s52, 34603008
v_mov_b32 v8, s51
buffer_store_dword v8, v7, s[40:43], s52 offen sc1
s_waitcnt vmcnt(0)
s_mov_b32 s50, 0
s_mov_b32 s49, 0
s_branch L_poll
L_go:
s_add_u32 s47, s47, s79
s_cmp_ge_u32 s47, 7
s_cselect_b32 s48, 7, 0
s_sub_u32 s47, s47, s48
s_and_b32 s46, s46, 3
s_mul_i32 s48, s81, 1835008
s_lshl_b32 s49, s47, 18
s_add_u32 s48, s48, s49
s_lshl_b32 s49, s82, 16
s_add_u32 s48, s48, s49
s_lshl_b32 s49, s46, 14
s_add_u32 s48, s48, s49
s_add_u32 s48, s48, 0
buffer_load_dwordx4 v[16:19], v5, s[40:43], s48 offen offset:0 sc1
buffer_load_dwordx4 v[20:23], v5, s[40:43], s48 offen offset:1024 sc1
buffer_load_dwordx4 v[24:27], v5, s[40:43], s48 offen offset:2048 sc1
buffer_load_dwordx4 v[28:31], v5, s[40:43], s48 offen offset:3072 sc1
s_add_u32 s48, s48, 4096
buffer_load_dwordx4 v[32:35], v5, s[40:43], s48 offen offset:0 sc1
buffer_load_dwordx4 v[36:39], v5, s[40:43], s48 offen offset:1024 sc1
buffer_load_dwordx4 v[40:43], v5, s[40:43], s48 offen offset:2048 sc1
buffer_load_dwordx4 v[44:47], v5, s[40:43], s48 offen offset:3072 sc1
s_add_u32 s48, s48, 4096
buffer_load_dwordx4 v[48:51], v5, s[40:43], s48 offen offset:0 sc1
buffer_load_dwordx4 v[52:55], v5, s[40:43], s48 offen offset:1024 sc1
buffer_load_dwordx4 v[56:59], v5, s[40:43], s48 offen offset:2048 sc1
buffer_load_dwordx4 v[60:63], v5, s[40:43], s48 offen offset:3072 sc1
s_add_u32 s48, s48, 4096
buffer_load_dwordx4 v[64:67], v5, s[40:43], s48 offen offset:0 sc1
buffer_load_dwordx4 v[68:71], v5, s[40:43], s48 offen offset:1024 sc1
buffer_load_dwordx4 v[72:75], v5, s[40:43], s48 offen offset:2048 sc1
buffer_load_dwordx4 v[76:79], v5, s[40:43], s48 offen offset:3072 sc1
s_add_u32 s48, s48, 4096
s_lshl_b32 s48, s7, 2
s_add_u32 s48, s48, s82
s_mul_i32 s48, s48, 57344
s_lshl_b32 s49, s46, 5
s_add_u32 s48, s48, s49
s_mul_i32 s49, s5, 896
s_add_u32 s48, s48, s49
s_lshl_b32 s49, s47, 7
s_add_u32 s48, s48, s49
s_waitcnt vmcnt(15)
v_lshlrev_b32 v80, 16, v16
v_and_b32 v81, 0xffff0000, v16
v_lshlrev_b32 v82, 16, v17
v_and_b32 v83, 0xffff0000, v17
v_lshlrev_b32 v84, 16, v18
v_and_b32 v85, 0xffff0000, v18
v_lshlrev_b32 v86, 16, v19
v_and_b32 v87, 0xffff0000, v19
s_waitcnt vmcnt(14)
v_lshlrev_b32 v12, 16, v20
v_and_b32 v13, 0xffff0000, v20
v_pk_add_f32 v[80:81], v[80:81], v[12:13]
v_lshlrev_b32 v12, 16, v21
v_and_b32 v13, 0xffff0000, v21
v_pk_add_f32 v[82:83], v[82:83], v[12:13]
v_lshlrev_b32 v12, 16, v22
v_and_b32 v13, 0xffff0000, v22
v_pk_add_f32 v[84:85], v[84:85], v[12:13]
v_lshlrev_b32 v12, 16, v23
v_and_b32 v13, 0xffff0000, v23
v_pk_add_f32 v[86:87], v[86:87], v[12:13]
s_waitcnt vmcnt(13)
v_lshlrev_b32 v12, 16, v24
v_and_b32 v13, 0xffff0000, v24
v_pk_add_f32 v[80:81], v[80:81], v[12:13]
v_lshlrev_b32 v12, 16, v25
v_and_b32 v13, 0xffff0000, v25
v_pk_add_f32 v[82:83], v[82:83], v[12:13]
v_lshlrev_b32 v12, 16, v26
v_and_b32 v13, 0xffff0000, v26
v_pk_add_f32 v[84:85], v[84:85], v[12:13]
v_lshlrev_b32 v12, 16, v27
v_and_b32 v13, 0xffff0000, v27
v_pk_add_f32 v[86:87], v[86:87], v[12:13]
s_waitcnt vmcnt(12)
v_lshlrev_b32 v12, 16, v28
v_and_b32 v13, 0xffff0000, v28
v_pk_add_f32 v[80:81], v[80:81], v[12:13]
v_lshlrev_b32 v12, 16, v29
v_and_b32 v13, 0xffff0000, v29
v_pk_add_f32 v[82:83], v[82:83], v[12:13]
v_lshlrev_b32 v12, 16, v30
v_and_b32 v13, 0xffff0000, v30
v_pk_add_f32 v[84:85], v[84:85], v[12:13]
v_lshlrev_b32 v12, 16, v31
v_and_b32 v13, 0xffff0000, v31
v_pk_add_f32 v[86:87], v[86:87], v[12:13]
s_waitcnt vmcnt(11)
v_lshlrev_b32 v12, 16, v32
v_and_b32 v13, 0xffff0000, v32
v_pk_add_f32 v[80:81], v[80:81], v[12:13]
v_lshlrev_b32 v12, 16, v33
v_and_b32 v13, 0xffff0000, v33
v_pk_add_f32 v[82:83], v[82:83], v[12:13]
v_lshlrev_b32 v12, 16, v34
v_and_b32 v13, 0xffff0000, v34
v_pk_add_f32 v[84:85], v[84:85], v[12:13]
v_lshlrev_b32 v12, 16, v35
v_and_b32 v13, 0xffff0000, v35
v_pk_add_f32 v[86:87], v[86:87], v[12:13]
s_waitcnt vmcnt(10)
v_lshlrev_b32 v12, 16, v36
v_and_b32 v13, 0xffff0000, v36
v_pk_add_f32 v[80:81], v[80:81], v[12:13]
v_lshlrev_b32 v12, 16, v37
v_and_b32 v13, 0xffff0000, v37
v_pk_add_f32 v[82:83], v[82:83], v[12:13]
v_lshlrev_b32 v12, 16, v38
v_and_b32 v13, 0xffff0000, v38
v_pk_add_f32 v[84:85], v[84:85], v[12:13]
v_lshlrev_b32 v12, 16, v39
v_and_b32 v13, 0xffff0000, v39
v_pk_add_f32 v[86:87], v[86:87], v[12:13]
s_waitcnt vmcnt(9)
v_lshlrev_b32 v12, 16, v40
v_and_b32 v13, 0xffff0000, v40
v_pk_add_f32 v[80:81], v[80:81], v[12:13]
v_lshlrev_b32 v12, 16, v41
v_and_b32 v13, 0xffff0000, v41
v_pk_add_f32 v[82:83], v[82:83], v[12:13]
v_lshlrev_b32 v12, 16, v42
v_and_b32 v13, 0xffff0000, v42
v_pk_add_f32 v[84:85], v[84:85], v[12:13]
v_lshlrev_b32 v12, 16, v43
v_and_b32 v13, 0xffff0000, v43
v_pk_add_f32 v[86:87], v[86:87], v[12:13]
s_waitcnt vmcnt(8)
v_lshlrev_b32 v12, 16, v44
v_and_b32 v13, 0xffff0000, v44
v_pk_add_f32 v[80:81], v[80:81], v[12:13]
v_lshlrev_b32 v12, 16, v45
v_and_b32 v13, 0xffff0000, v45
v_pk_add_f32 v[82:83], v[82:83], v[12:13]
v_lshlrev_b32 v12, 16, v46
v_and_b32 v13, 0xffff0000, v46
v_pk_add_f32 v[84:85], v[84:85], v[12:13]
v_lshlrev_b32 v12, 16, v47
v_and_b32 v13, 0xffff0000, v47
v_pk_add_f32 v[86:87], v[86:87], v[12:13]
s_waitcnt vmcnt(7)
v_lshlrev_b32 v12, 16, v48
v_and_b32 v13, 0xffff0000, v48
v_pk_add_f32 v[80:81], v[80:81], v[12:13]
v_lshlrev_b32 v12, 16, v49
v_and_b32 v13, 0xffff0000, v49
v_pk_add_f32 v[82:83], v[82:83], v[12:13]
v_lshlrev_b32 v12, 16, v50
v_and_b32 v13, 0xffff0000, v50
v_pk_add_f32 v[84:85], v[84:85], v[12:13]
v_lshlrev_b32 v12, 16, v51
v_and_b32 v13, 0xffff0000, v51
v_pk_add_f32 v[86:87], v[86:87], v[12:13]
s_waitcnt vmcnt(6)
v_lshlrev_b32 v12, 16, v52
v_and_b32 v13, 0xffff0000, v52
v_pk_add_f32 v[80:81], v[80:81], v[12:13]
v_lshlrev_b32 v12, 16, v53
v_and_b32 v13, 0xffff0000, v53
v_pk_add_f32 v[82:83], v[82:83], v[12:13]
v_lshlrev_b32 v12, 16, v54
v_and_b32 v13, 0xffff0000, v54
v_pk_add_f32 v[84:85], v[84:85], v[12:13]
v_lshlrev_b32 v12, 16, v55
v_and_b32 v13, 0xffff0000, v55
v_pk_add_f32 v[86:87], v[86:87], v[12:13]
s_waitcnt vmcnt(5)
v_lshlrev_b32 v12, 16, v56
v_and_b32 v13, 0xffff0000, v56
v_pk_add_f32 v[80:81], v[80:81], v[12:13]
v_lshlrev_b32 v12, 16, v57
v_and_b32 v13, 0xffff0000, v57
v_pk_add_f32 v[82:83], v[82:83], v[12:13]
v_lshlrev_b32 v12, 16, v58
v_and_b32 v13, 0xffff0000, v58
v_pk_add_f32 v[84:85], v[84:85], v[12:13]
v_lshlrev_b32 v12, 16, v59
v_and_b32 v13, 0xffff0000, v59
v_pk_add_f32 v[86:87], v[86:87], v[12:13]
s_waitcnt vmcnt(4)
v_lshlrev_b32 v12, 16, v60
v_and_b32 v13, 0xffff0000, v60
v_pk_add_f32 v[80:81], v[80:81], v[12:13]
v_lshlrev_b32 v12, 16, v61
v_and_b32 v13, 0xffff0000, v61
v_pk_add_f32 v[82:83], v[82:83], v[12:13]
v_lshlrev_b32 v12, 16, v62
v_and_b32 v13, 0xffff0000, v62
v_pk_add_f32 v[84:85], v[84:85], v[12:13]
v_lshlrev_b32 v12, 16, v63
v_and_b32 v13, 0xffff0000, v63
v_pk_add_f32 v[86:87], v[86:87], v[12:13]
s_waitcnt vmcnt(3)
v_lshlrev_b32 v12, 16, v64
v_and_b32 v13, 0xffff0000, v64
v_pk_add_f32 v[80:81], v[80:81], v[12:13]
v_lshlrev_b32 v12, 16, v65
v_and_b32 v13, 0xffff0000, v65
v_pk_add_f32 v[82:83], v[82:83], v[12:13]
v_lshlrev_b32 v12, 16, v66
v_and_b32 v13, 0xffff0000, v66
v_pk_add_f32 v[84:85], v[84:85], v[12:13]
v_lshlrev_b32 v12, 16, v67
v_and_b32 v13, 0xffff0000, v67
v_pk_add_f32 v[86:87], v[86:87], v[12:13]
s_waitcnt vmcnt(2)
v_lshlrev_b32 v12, 16, v68
v_and_b32 v13, 0xffff0000, v68
v_pk_add_f32 v[80:81], v[80:81], v[12:13]
v_lshlrev_b32 v12, 16, v69
v_and_b32 v13, 0xffff0000, v69
v_pk_add_f32 v[82:83], v[82:83], v[12:13]
v_lshlrev_b32 v12, 16, v70
v_and_b32 v13, 0xffff0000, v70
v_pk_add_f32 v[84:85], v[84:85], v[12:13]
v_lshlrev_b32 v12, 16, v71
v_and_b32 v13, 0xffff0000, v71
v_pk_add_f32 v[86:87], v[86:87], v[12:13]
s_waitcnt vmcnt(1)
v_lshlrev_b32 v12, 16, v72
v_and_b32 v13, 0xffff0000, v72
v_pk_add_f32 v[80:81], v[80:81], v[12:13]
v_lshlrev_b32 v12, 16, v73
v_and_b32 v13, 0xffff0000, v73
v_pk_add_f32 v[82:83], v[82:83], v[12:13]
v_lshlrev_b32 v12, 16, v74
v_and_b32 v13, 0xffff0000, v74
v_pk_add_f32 v[84:85], v[84:85], v[12:13]
v_lshlrev_b32 v12, 16, v75
v_and_b32 v13, 0xffff0000, v75
v_pk_add_f32 v[86:87], v[86:87], v[12:13]
s_waitcnt vmcnt(0)
v_lshlrev_b32 v12, 16, v76
v_and_b32 v13, 0xffff0000, v76
v_pk_add_f32 v[80:81], v[80:81], v[12:13]
v_lshlrev_b32 v12, 16, v77
v_and_b32 v13, 0xffff0000, v77
v_pk_add_f32 v[82:83], v[82:83], v[12:13]
v_lshlrev_b32 v12, 16, v78
v_and_b32 v13, 0xffff0000, v78
v_pk_add_f32 v[84:85], v[84:85], v[12:13]
v_lshlrev_b32 v12, 16, v79
v_and_b32 v13, 0xffff0000, v79
v_pk_add_f32 v[86:87], v[86:87], v[12:13]
v_cvt_pk_bf16_f32 v12, v80, v81
v_cvt_pk_bf16_f32 v13, v82, v83
v_cvt_pk_bf16_f32 v14, v84, v85
v_cvt_pk_bf16_f32 v15, v86, v87
buffer_store_dwordx4 v[12:15], v6, s[92:95], s48 offen
s_branch L_item
L_fin:
s_cmp_eq_u32 s59, 1
s_cbranch_scc1 L_chk
s_cmp_lg_u32 s59, 2
s_cbranch_scc1 L_nob2
s_barrier
L_nob2:
L_main_end:
s_endpgm
L_compute:
s_cmp_ge_u32 s7, 7
s_cselect_b32 s56, 0, s7
s_lshl_b32 s81, s5, 3
s_add_u32 s81, s81, s7
s_mov_b32 s79, s56
s_waitcnt lgkmcnt(0)
s_mov_b32 s40, s18
s_and_b32 s41, s19, 0xffff
s_mov_b32 s42, 268435456
s_mov_b32 s43, 0x20000
s_mov_b32 s88, s86
s_and_b32 s89, s87, 0xffff
s_mov_b32 s90, 256
s_mov_b32 s91, 0x20000
s_mov_b32 s92, s84
s_and_b32 s93, s85, 0xffff
s_mov_b32 s94, 1835008
s_mov_b32 s95, 0x20000
s_setprio 1
s_mul_i32 s45, s81, 3584
s_lshl_b32 s46, s6, 2
s_add_u32 s45, s45, s46
s_add_u32 s45, s45, 33554432
v_lshl_add_u32 v1, v0, 7, s45
s_lshl_b32 s46, s81, 2
s_lshr_b32 s47, s6, 2
s_add_u32 s46, s46, s47
s_lshl_b32 s46, s46, 7
s_and_b32 s47, s6, 3
s_lshl_b32 s47, s47, 2
s_add_u32 s46, s46, s47
s_add_u32 s46, s46, 34602560
v_lshl_add_u32 v2, v0, 4, s46
v_cmp_gt_u32 vcc, 28, v0
s_nop 3
v_cndmask_b32 v1, v2, v1, vcc
v_bfrev_b32 v2, 1
v_cmp_gt_u32 vcc, 35, v0
s_nop 3
v_cndmask_b32 v1, v2, v1, vcc
buffer_load_dword v252, v1, s[40:43], 0 offen sc1
s_lshl_b32 s46, s44, 7
s_add_u32 s57, s45, s46
v_cmp_eq_u32 vcc, 0, v0
s_nop 3
v_cndmask_b32 v251, v2, v0, vcc
s_lshl_b32 s46, s81, 4
s_add_u32 s80, s46, s6
s_lshr_b32 s45, s44, 1
s_and_b32 s46, s44, 1
v_and_b32 v1, 3, v0
v_bfe_u32 v2, v0, 2, 2
v_bfe_u32 v3, v0, 4, 1
v_lshrrev_b32 v4, 5, v0
v_lshlrev_b32 v5, 1, v1
v_and_b32 v5, 2, v5
v_lshrrev_b32 v6, 1, v1
v_or_b32 v5, v5, v6
v_lshlrev_b32 v7, 5, v3
v_lshl_add_u32 v8, v5, 3, v7
v_lshl_add_u32 v9, v1, 3, v7
v_lshl_add_u32 v10, v4, 3, v2
v_lshl_add_u32 v10, v10, 9, v8
v_xor_b32 v11, 0, v2
v_lshl_add_u32 v232, v11, 6, v10
v_xor_b32 v11, 1, v2
v_lshl_add_u32 v233, v11, 6, v10
v_xor_b32 v11, 2, v2
v_lshl_add_u32 v234, v11, 6, v10
v_xor_b32 v11, 3, v2
v_lshl_add_u32 v235, v11, 6, v10
v_lshl_add_u32 v10, v4, 2, v2
v_lshl_add_u32 v12, v10, 9, v9
s_cmp_eq_u32 s45, 0
s_cselect_b32 s47, 8, 9
s_cselect_b32 s48, 5, 0
s_cselect_b32 s49, 6, 7
s_cselect_b32 s50, 2, 3
s_lshl_b32 s47, s47, 14
s_lshl_b32 s48, s48, 14
s_lshl_b32 s49, s49, 14
s_lshl_b32 s50, s50, 14
v_xor_b32 v11, 0, v2
v_lshl_add_u32 v11, v11, 6, v12
v_add_u32 v240, s47, v11
v_add_u32 v244, s48, v11
v_xor_b32 v11, 1, v2
v_lshl_add_u32 v11, v11, 6, v12
v_add_u32 v241, s47, v11
v_add_u32 v245, s48, v11
v_xor_b32 v11, 2, v2
v_lshl_add_u32 v11, v11, 6, v12
v_add_u32 v242, s47, v11
v_add_u32 v246, s48, v11
v_xor_b32 v11, 3, v2
v_lshl_add_u32 v11, v11, 6, v12
v_add_u32 v243, s47, v11
v_add_u32 v247, s48, v11
v_lshl_add_u32 v10, v10, 7, v8
v_lshrrev_b32 v11, 1, v2
v_lshl_add_u32 v248, v11, 6, v10
v_xor_b32 v11, 1, v11
v_lshl_add_u32 v249, v11, 6, v10
v_add_u32 v248, 16384, v248
v_add_u32 v249, 16384, v249
v_and_b32 v10, 31, v0
s_lshl_b32 s51, s44, 5
v_add_u32 v11, s51, v10
v_bfe_u32 v12, v11, 1, 3
v_xor_b32 v12, v12, v4
v_lshlrev_b32 v12, 4, v12
v_lshl_add_u32 v12, v11, 7, v12
v_add_u32 v236, 65536, v12
v_and_b32 v11, 15, v0
v_xor_b32 v11, v11, v4
v_lshlrev_b32 v11, 4, v11
v_lshl_add_u32 v11, v10, 9, v11
v_add_u32 v238, s49, v11
v_add_u32 v239, s50, v11
s_lshl_b32 s51, s44, 16
v_lshl_add_u32 v250, v0, 4, s51
s_lshl_b32 s52, s5, 3
s_add_u32 s52, s52, s7
s_lshl_b32 s52, s52, 4
s_add_u32 s52, s52, s6
s_mul_i32 s52, s52, 114688
s_add_u32 s52, s52, 0
s_mul_i32 s52, s81, 1835008
s_lshl_b32 s53, s6, 10
s_add_u32 s52, s52, s53
s_mov_b32 s54, 0x3db8aa3b
s_mov_b32 s58, s54
s_mov_b32 s59, s54
s_barrier
ds_read_b128 v[160:163], v236
ds_read_b64_tr_b16 v[128:129], v232 offset:0
ds_read_b64_tr_b16 v[130:131], v232 offset:2048
ds_read_b64_tr_b16 v[132:133], v233 offset:0
ds_read_b64_tr_b16 v[134:135], v233 offset:2048
ds_read_b64_tr_b16 v[136:137], v234 offset:0
ds_read_b64_tr_b16 v[138:139], v234 offset:2048
ds_read_b64_tr_b16 v[140:141], v235 offset:0
ds_read_b64_tr_b16 v[142:143], v235 offset:2048
ds_read_b64_tr_b16 v[144:145], v232 offset:256
ds_read_b64_tr_b16 v[146:147], v232 offset:2304
ds_read_b64_tr_b16 v[148:149], v233 offset:256
ds_read_b64_tr_b16 v[150:151], v233 offset:2304
ds_read_b64_tr_b16 v[152:153], v234 offset:256
ds_read_b64_tr_b16 v[154:155], v234 offset:2304
s_waitcnt lgkmcnt(12)
v_mfma_f32_32x32x16_bf16 v[0:15], v[128:131], v[160:163], 0
ds_read_b64_tr_b16 v[156:157], v235 offset:256
ds_read_b64_tr_b16 v[158:159], v235 offset:2304
s_waitcnt lgkmcnt(12)
v_mfma_f32_32x32x16_bf16 v[16:31], v[132:135], v[160:163], 0
v_xor_b32 v237, 32, v236
ds_read_b128 v[164:167], v237
ds_read_b64_tr_b16 v[128:129], v232 offset:8192
ds_read_b64_tr_b16 v[130:131], v232 offset:10240
s_waitcnt lgkmcnt(13)
v_mfma_f32_32x32x16_bf16 v[32:47], v[136:139], v[160:163], 0
ds_read_b64_tr_b16 v[132:133], v233 offset:8192
ds_read_b64_tr_b16 v[134:135], v233 offset:10240
s_waitcnt lgkmcnt(13)
v_mfma_f32_32x32x16_bf16 v[48:63], v[140:143], v[160:163], 0
ds_read_b64_tr_b16 v[136:137], v234 offset:8192
ds_read_b64_tr_b16 v[138:139], v234 offset:10240
s_waitcnt lgkmcnt(13)
v_mfma_f32_32x32x16_bf16 v[64:79], v[144:147], v[160:163], 0
ds_read_b64_tr_b16 v[140:141], v235 offset:8192
ds_read_b64_tr_b16 v[142:143], v235 offset:10240
s_waitcnt lgkmcnt(13)
v_mfma_f32_32x32x16_bf16 v[80:95], v[148:151], v[160:163], 0
ds_read_b64_tr_b16 v[144:145], v232 offset:8448
ds_read_b64_tr_b16 v[146:147], v232 offset:10496
s_waitcnt lgkmcnt(13)
v_mfma_f32_32x32x16_bf16 v[96:111], v[152:155], v[160:163], 0
ds_read_b64_tr_b16 v[148:149], v233 offset:8448
ds_read_b64_tr_b16 v[150:151], v233 offset:10496
s_waitcnt lgkmcnt(13)
v_mfma_f32_32x32x16_bf16 v[112:127], v[156:159], v[160:163], 0
ds_read_b64_tr_b16 v[152:153], v234 offset:8448
ds_read_b64_tr_b16 v[154:155], v234 offset:10496
s_waitcnt lgkmcnt(12)
v_mfma_f32_32x32x16_bf16 v[0:15], v[128:131], v[164:167], v[0:15]
s_waitcnt vmcnt(0)
s_mov_b32 s78, 0
L_tag:
s_add_u32 s78, s78, 1
v_cmp_eq_u32 vcc, s78, v252
s_nop 3
s_cbranch_vccnz L_tag
v_mov_b32 v252, s78
s_and_b32 s82, s81, 7
s_add_u32 s82, s82, 1
s_cmp_eq_u32 s44, 0
s_cselect_b32 s82, s82, 99
ds_read_b64_tr_b16 v[156:157], v235 offset:8448
ds_read_b64_tr_b16 v[158:159], v235 offset:10496
s_waitcnt lgkmcnt(12)
v_mfma_f32_32x32x16_bf16 v[16:31], v[132:135], v[164:167], v[16:31]
s_waitcnt lgkmcnt(10)
v_mfma_f32_32x32x16_bf16 v[32:47], v[136:139], v[164:167], v[32:47]
s_waitcnt lgkmcnt(8)
v_mfma_f32_32x32x16_bf16 v[48:63], v[140:143], v[164:167], v[48:63]
s_mov_b32 s83, 2
L_loopA:
s_waitcnt lgkmcnt(6)
v_mfma_f32_32x32x16_bf16 v[64:79], v[144:147], v[164:167], v[64:79]
s_waitcnt lgkmcnt(0)
s_barrier
v_add_u32 v232, 0x4000, v232
v_add_u32 v233, 0x4000, v233
v_add_u32 v234, 0x4000, v234
v_add_u32 v235, 0x4000, v235
v_xor_b32 v237, 64, v236
ds_read_b128 v[160:163], v237
ds_read_b64_tr_b16 v[128:129], v232 offset:0
ds_read_b64_tr_b16 v[130:131], v232 offset:2048
ds_read_b64_tr_b16 v[132:133], v233 offset:0
ds_read_b64_tr_b16 v[134:135], v233 offset:2048
s_waitcnt lgkmcnt(9)
v_mfma_f32_32x32x16_bf16 v[80:95], v[148:151], v[164:167], v[80:95]
ds_read_b64_tr_b16 v[136:137], v234 offset:0
ds_read_b64_tr_b16 v[138:139], v234 offset:2048
ds_read_b64_tr_b16 v[140:141], v235 offset:0
ds_read_b64_tr_b16 v[142:143], v235 offset:2048
s_waitcnt lgkmcnt(11)
v_mfma_f32_32x32x16_bf16 v[96:111], v[152:155], v[164:167], v[96:111]
ds_read_b64_tr_b16 v[144:145], v232 offset:256
ds_read_b64_tr_b16 v[146:147], v232 offset:2304
ds_read_b64_tr_b16 v[148:149], v233 offset:256
ds_read_b64_tr_b16 v[150:151], v233 offset:2304
s_waitcnt lgkmcnt(13)
v_mfma_f32_32x32x16_bf16 v[112:127], v[156:159], v[164:167], v[112:127]
ds_read_b64_tr_b16 v[152:153], v234 offset:256
ds_read_b64_tr_b16 v[154:155], v234 offset:2304
s_waitcnt lgkmcnt(12)
v_mfma_f32_32x32x16_bf16 v[0:15], v[128:131], v[160:163], v[0:15]
ds_read_b64_tr_b16 v[156:157], v235 offset:256
ds_read_b64_tr_b16 v[158:159], v235 offset:2304
s_waitcnt lgkmcnt(12)
v_mfma_f32_32x32x16_bf16 v[16:31], v[132:135], v[160:163], v[16:31]
v_xor_b32 v237, 96, v236
ds_read_b128 v[164:167], v237
ds_read_b64_tr_b16 v[128:129], v232 offset:8192
ds_read_b64_tr_b16 v[130:131], v232 offset:10240
s_waitcnt lgkmcnt(13)
v_mfma_f32_32x32x16_bf16 v[32:47], v[136:139], v[160:163], v[32:47]
ds_read_b64_tr_b16 v[132:133], v233 offset:8192
ds_read_b64_tr_b16 v[134:135], v233 offset:10240
s_waitcnt lgkmcnt(13)
v_mfma_f32_32x32x16_bf16 v[48:63], v[140:143], v[160:163], v[48:63]
ds_read_b64_tr_b16 v[136:137], v234 offset:8192
ds_read_b64_tr_b16 v[138:139], v234 offset:10240
s_waitcnt lgkmcnt(13)
v_mfma_f32_32x32x16_bf16 v[64:79], v[144:147], v[160:163], v[64:79]
ds_read_b64_tr_b16 v[140:141], v235 offset:8192
ds_read_b64_tr_b16 v[142:143], v235 offset:10240
s_waitcnt lgkmcnt(13)
v_mfma_f32_32x32x16_bf16 v[80:95], v[148:151], v[160:163], v[80:95]
ds_read_b64_tr_b16 v[144:145], v232 offset:8448
ds_read_b64_tr_b16 v[146:147], v232 offset:10496
s_waitcnt lgkmcnt(13)
v_mfma_f32_32x32x16_bf16 v[96:111], v[152:155], v[160:163], v[96:111]
ds_read_b64_tr_b16 v[148:149], v233 offset:8448
ds_read_b64_tr_b16 v[150:151], v233 offset:10496
s_waitcnt lgkmcnt(13)
v_mfma_f32_32x32x16_bf16 v[112:127], v[156:159], v[160:163], v[112:127]
ds_read_b64_tr_b16 v[152:153], v234 offset:8448
ds_read_b64_tr_b16 v[154:155], v234 offset:10496
s_waitcnt lgkmcnt(12)
v_mfma_f32_32x32x16_bf16 v[0:15], v[128:131], v[164:167], v[0:15]
s_sub_u32 s82, s82, 1
s_cbranch_scc0 L_nopub1
buffer_store_byte v252, v251, s[88:91], s80 offen sc1
L_nopub1:
ds_read_b64_tr_b16 v[156:157], v235 offset:8448
ds_read_b64_tr_b16 v[158:159], v235 offset:10496
s_waitcnt lgkmcnt(12)
v_mfma_f32_32x32x16_bf16 v[16:31], v[132:135], v[164:167], v[16:31]
s_waitcnt lgkmcnt(10)
v_mfma_f32_32x32x16_bf16 v[32:47], v[136:139], v[164:167], v[32:47]
s_waitcnt lgkmcnt(8)
v_mfma_f32_32x32x16_bf16 v[48:63], v[140:143], v[164:167], v[48:63]
s_waitcnt lgkmcnt(6)
v_mfma_f32_32x32x16_bf16 v[64:79], v[144:147], v[164:167], v[64:79]
s_waitcnt lgkmcnt(0)
s_barrier
v_add_u32 v232, 0x4000, v232
v_add_u32 v233, 0x4000, v233
v_add_u32 v234, 0x4000, v234
v_add_u32 v235, 0x4000, v235
v_add_u32 v236, 0x4000, v236
ds_read_b128 v[160:163], v236
ds_read_b64_tr_b16 v[128:129], v232 offset:0
ds_read_b64_tr_b16 v[130:131], v232 offset:2048
ds_read_b64_tr_b16 v[132:133], v233 offset:0
ds_read_b64_tr_b16 v[134:135], v233 offset:2048
s_waitcnt lgkmcnt(9)
v_mfma_f32_32x32x16_bf16 v[80:95], v[148:151], v[164:167], v[80:95]
ds_read_b64_tr_b16 v[136:137], v234 offset:0
ds_read_b64_tr_b16 v[138:139], v234 offset:2048
ds_read_b64_tr_b16 v[140:141], v235 offset:0
ds_read_b64_tr_b16 v[142:143], v235 offset:2048
s_waitcnt lgkmcnt(11)
v_mfma_f32_32x32x16_bf16 v[96:111], v[152:155], v[164:167], v[96:111]
ds_read_b64_tr_b16 v[144:145], v232 offset:256
ds_read_b64_tr_b16 v[146:147], v232 offset:2304
ds_read_b64_tr_b16 v[148:149], v233 offset:256
ds_read_b64_tr_b16 v[150:151], v233 offset:2304
s_waitcnt lgkmcnt(13)
v_mfma_f32_32x32x16_bf16 v[112:127], v[156:159], v[164:167], v[112:127]
ds_read_b64_tr_b16 v[152:153], v234 offset:256
ds_read_b64_tr_b16 v[154:155], v234 offset:2304
s_waitcnt lgkmcnt(12)
v_mfma_f32_32x32x16_bf16 v[0:15], v[128:131], v[160:163], v[0:15]
ds_read_b64_tr_b16 v[156:157], v235 offset:256
ds_read_b64_tr_b16 v[158:159], v235 offset:2304
s_waitcnt lgkmcnt(12)
v_mfma_f32_32x32x16_bf16 v[16:31], v[132:135], v[160:163], v[16:31]
v_xor_b32 v237, 32, v236
ds_read_b128 v[164:167], v237
ds_read_b64_tr_b16 v[128:129], v232 offset:8192
ds_read_b64_tr_b16 v[130:131], v232 offset:10240
s_waitcnt lgkmcnt(13)
v_mfma_f32_32x32x16_bf16 v[32:47], v[136:139], v[160:163], v[32:47]
ds_read_b64_tr_b16 v[132:133], v233 offset:8192
ds_read_b64_tr_b16 v[134:135], v233 offset:10240
s_waitcnt lgkmcnt(13)
v_mfma_f32_32x32x16_bf16 v[48:63], v[140:143], v[160:163], v[48:63]
ds_read_b64_tr_b16 v[136:137], v234 offset:8192
ds_read_b64_tr_b16 v[138:139], v234 offset:10240
s_waitcnt lgkmcnt(13)
v_mfma_f32_32x32x16_bf16 v[64:79], v[144:147], v[160:163], v[64:79]
ds_read_b64_tr_b16 v[140:141], v235 offset:8192
ds_read_b64_tr_b16 v[142:143], v235 offset:10240
s_waitcnt lgkmcnt(13)
v_mfma_f32_32x32x16_bf16 v[80:95], v[148:151], v[160:163], v[80:95]
ds_read_b64_tr_b16 v[144:145], v232 offset:8448
ds_read_b64_tr_b16 v[146:147], v232 offset:10496
s_waitcnt lgkmcnt(13)
v_mfma_f32_32x32x16_bf16 v[96:111], v[152:155], v[160:163], v[96:111]
ds_read_b64_tr_b16 v[148:149], v233 offset:8448
ds_read_b64_tr_b16 v[150:151], v233 offset:10496
s_waitcnt lgkmcnt(13)
v_mfma_f32_32x32x16_bf16 v[112:127], v[156:159], v[160:163], v[112:127]
ds_read_b64_tr_b16 v[152:153], v234 offset:8448
ds_read_b64_tr_b16 v[154:155], v234 offset:10496
s_waitcnt lgkmcnt(12)
v_mfma_f32_32x32x16_bf16 v[0:15], v[128:131], v[164:167], v[0:15]
s_sub_u32 s82, s82, 1
s_cbranch_scc0 L_nopub2
buffer_store_byte v252, v251, s[88:91], s80 offen sc1
L_nopub2:
ds_read_b64_tr_b16 v[156:157], v235 offset:8448
ds_read_b64_tr_b16 v[158:159], v235 offset:10496
s_waitcnt lgkmcnt(12)
v_mfma_f32_32x32x16_bf16 v[16:31], v[132:135], v[164:167], v[16:31]
s_waitcnt lgkmcnt(10)
v_mfma_f32_32x32x16_bf16 v[32:47], v[136:139], v[164:167], v[32:47]
s_waitcnt lgkmcnt(8)
v_mfma_f32_32x32x16_bf16 v[48:63], v[140:143], v[164:167], v[48:63]
s_waitcnt lgkmcnt(6)
v_mfma_f32_32x32x16_bf16 v[64:79], v[144:147], v[164:167], v[64:79]
s_waitcnt lgkmcnt(0)
s_barrier
v_add_u32 v232, 0x4000, v232
v_add_u32 v233, 0x4000, v233
v_add_u32 v234, 0x4000, v234
v_add_u32 v235, 0x4000, v235
v_xor_b32 v237, 64, v236
ds_read_b128 v[160:163], v237
ds_read_b64_tr_b16 v[128:129], v232 offset:0
ds_read_b64_tr_b16 v[130:131], v232 offset:2048
ds_read_b64_tr_b16 v[132:133], v233 offset:0
ds_read_b64_tr_b16 v[134:135], v233 offset:2048
s_waitcnt lgkmcnt(9)
v_mfma_f32_32x32x16_bf16 v[80:95], v[148:151], v[164:167], v[80:95]
ds_read_b64_tr_b16 v[136:137], v234 offset:0
ds_read_b64_tr_b16 v[138:139], v234 offset:2048
ds_read_b64_tr_b16 v[140:141], v235 offset:0
ds_read_b64_tr_b16 v[142:143], v235 offset:2048
s_waitcnt lgkmcnt(11)
v_mfma_f32_32x32x16_bf16 v[96:111], v[152:155], v[164:167], v[96:111]
ds_read_b64_tr_b16 v[144:145], v232 offset:256
ds_read_b64_tr_b16 v[146:147], v232 offset:2304
ds_read_b64_tr_b16 v[148:149], v233 offset:256
ds_read_b64_tr_b16 v[150:151], v233 offset:2304
s_waitcnt lgkmcnt(13)
v_mfma_f32_32x32x16_bf16 v[112:127], v[156:159], v[164:167], v[112:127]
ds_read_b64_tr_b16 v[152:153], v234 offset:256
ds_read_b64_tr_b16 v[154:155], v234 offset:2304
s_waitcnt lgkmcnt(12)
v_mfma_f32_32x32x16_bf16 v[0:15], v[128:131], v[160:163], v[0:15]
ds_read_b64_tr_b16 v[156:157], v235 offset:256
ds_read_b64_tr_b16 v[158:159], v235 offset:2304
s_waitcnt lgkmcnt(12)
v_mfma_f32_32x32x16_bf16 v[16:31], v[132:135], v[160:163], v[16:31]
v_xor_b32 v237, 96, v236
ds_read_b128 v[164:167], v237
ds_read_b64_tr_b16 v[128:129], v232 offset:8192
ds_read_b64_tr_b16 v[130:131], v232 offset:10240
s_waitcnt lgkmcnt(13)
v_mfma_f32_32x32x16_bf16 v[32:47], v[136:139], v[160:163], v[32:47]
ds_read_b64_tr_b16 v[132:133], v233 offset:8192
ds_read_b64_tr_b16 v[134:135], v233 offset:10240
s_waitcnt lgkmcnt(13)
v_mfma_f32_32x32x16_bf16 v[48:63], v[140:143], v[160:163], v[48:63]
ds_read_b64_tr_b16 v[136:137], v234 offset:8192
ds_read_b64_tr_b16 v[138:139], v234 offset:10240
s_waitcnt lgkmcnt(13)
v_mfma_f32_32x32x16_bf16 v[64:79], v[144:147], v[160:163], v[64:79]
ds_read_b64_tr_b16 v[140:141], v235 offset:8192
ds_read_b64_tr_b16 v[142:143], v235 offset:10240
s_waitcnt lgkmcnt(13)
v_mfma_f32_32x32x16_bf16 v[80:95], v[148:151], v[160:163], v[80:95]
ds_read_b64_tr_b16 v[144:145], v232 offset:8448
ds_read_b64_tr_b16 v[146:147], v232 offset:10496
s_waitcnt lgkmcnt(13)
v_mfma_f32_32x32x16_bf16 v[96:111], v[152:155], v[160:163], v[96:111]
ds_read_b64_tr_b16 v[148:149], v233 offset:8448
ds_read_b64_tr_b16 v[150:151], v233 offset:10496
s_waitcnt lgkmcnt(13)
v_mfma_f32_32x32x16_bf16 v[112:127], v[156:159], v[160:163], v[112:127]
ds_read_b64_tr_b16 v[152:153], v234 offset:8448
ds_read_b64_tr_b16 v[154:155], v234 offset:10496
s_waitcnt lgkmcnt(12)
v_mfma_f32_32x32x16_bf16 v[0:15], v[128:131], v[164:167], v[0:15]
s_sub_u32 s82, s82, 1
s_cbranch_scc0 L_nopub3
buffer_store_byte v252, v251, s[88:91], s80 offen sc1
L_nopub3:
ds_read_b64_tr_b16 v[156:157], v235 offset:8448
ds_read_b64_tr_b16 v[158:159], v235 offset:10496
s_waitcnt lgkmcnt(12)
v_mfma_f32_32x32x16_bf16 v[16:31], v[132:135], v[164:167], v[16:31]
s_waitcnt lgkmcnt(10)
v_mfma_f32_32x32x16_bf16 v[32:47], v[136:139], v[164:167], v[32:47]
s_waitcnt lgkmcnt(8)
v_mfma_f32_32x32x16_bf16 v[48:63], v[140:143], v[164:167], v[48:63]
s_waitcnt lgkmcnt(6)
v_mfma_f32_32x32x16_bf16 v[64:79], v[144:147], v[164:167], v[64:79]
s_waitcnt lgkmcnt(0)
s_barrier
v_add_u32 v232, 0xffff4000, v232
v_add_u32 v233, 0xffff4000, v233
v_add_u32 v234, 0xffff4000, v234
v_add_u32 v235, 0xffff4000, v235
v_add_u32 v236, 0xffffc000, v236
ds_read_b128 v[160:163], v236
ds_read_b64_tr_b16 v[128:129], v232 offset:0
ds_read_b64_tr_b16 v[130:131], v232 offset:2048
ds_read_b64_tr_b16 v[132:133], v233 offset:0
ds_read_b64_tr_b16 v[134:135], v233 offset:2048
s_waitcnt lgkmcnt(9)
v_mfma_f32_32x32x16_bf16 v[80:95], v[148:151], v[164:167], v[80:95]
ds_read_b64_tr_b16 v[136:137], v234 offset:0
ds_read_b64_tr_b16 v[138:139], v234 offset:2048
ds_read_b64_tr_b16 v[140:141], v235 offset:0
ds_read_b64_tr_b16 v[142:143], v235 offset:2048
s_waitcnt lgkmcnt(11)
v_mfma_f32_32x32x16_bf16 v[96:111], v[152:155], v[164:167], v[96:111]
ds_read_b64_tr_b16 v[144:145], v232 offset:256
ds_read_b64_tr_b16 v[146:147], v232 offset:2304
ds_read_b64_tr_b16 v[148:149], v233 offset:256
ds_read_b64_tr_b16 v[150:151], v233 offset:2304
s_waitcnt lgkmcnt(13)
v_mfma_f32_32x32x16_bf16 v[112:127], v[156:159], v[164:167], v[112:127]
ds_read_b64_tr_b16 v[152:153], v234 offset:256
ds_read_b64_tr_b16 v[154:155], v234 offset:2304
s_waitcnt lgkmcnt(12)
v_mfma_f32_32x32x16_bf16 v[0:15], v[128:131], v[160:163], v[0:15]
ds_read_b64_tr_b16 v[156:157], v235 offset:256
ds_read_b64_tr_b16 v[158:159], v235 offset:2304
s_waitcnt lgkmcnt(12)
v_mfma_f32_32x32x16_bf16 v[16:31], v[132:135], v[160:163], v[16:31]
v_xor_b32 v237, 32, v236
ds_read_b128 v[164:167], v237
ds_read_b64_tr_b16 v[128:129], v232 offset:8192
ds_read_b64_tr_b16 v[130:131], v232 offset:10240
s_waitcnt lgkmcnt(13)
v_mfma_f32_32x32x16_bf16 v[32:47], v[136:139], v[160:163], v[32:47]
ds_read_b64_tr_b16 v[132:133], v233 offset:8192
ds_read_b64_tr_b16 v[134:135], v233 offset:10240
s_waitcnt lgkmcnt(13)
v_mfma_f32_32x32x16_bf16 v[48:63], v[140:143], v[160:163], v[48:63]
ds_read_b64_tr_b16 v[136:137], v234 offset:8192
ds_read_b64_tr_b16 v[138:139], v234 offset:10240
s_waitcnt lgkmcnt(13)
v_mfma_f32_32x32x16_bf16 v[64:79], v[144:147], v[160:163], v[64:79]
ds_read_b64_tr_b16 v[140:141], v235 offset:8192
ds_read_b64_tr_b16 v[142:143], v235 offset:10240
s_waitcnt lgkmcnt(13)
v_mfma_f32_32x32x16_bf16 v[80:95], v[148:151], v[160:163], v[80:95]
ds_read_b64_tr_b16 v[144:145], v232 offset:8448
ds_read_b64_tr_b16 v[146:147], v232 offset:10496
s_waitcnt lgkmcnt(13)
v_mfma_f32_32x32x16_bf16 v[96:111], v[152:155], v[160:163], v[96:111]
ds_read_b64_tr_b16 v[148:149], v233 offset:8448
ds_read_b64_tr_b16 v[150:151], v233 offset:10496
s_waitcnt lgkmcnt(13)
v_mfma_f32_32x32x16_bf16 v[112:127], v[156:159], v[160:163], v[112:127]
ds_read_b64_tr_b16 v[152:153], v234 offset:8448
ds_read_b64_tr_b16 v[154:155], v234 offset:10496
s_waitcnt lgkmcnt(12)
v_mfma_f32_32x32x16_bf16 v[0:15], v[128:131], v[164:167], v[0:15]
s_sub_u32 s82, s82, 1
s_cbranch_scc0 L_nopub4
buffer_store_byte v252, v251, s[88:91], s80 offen sc1
L_nopub4:
ds_read_b64_tr_b16 v[156:157], v235 offset:8448
ds_read_b64_tr_b16 v[158:159], v235 offset:10496
s_waitcnt lgkmcnt(12)
v_mfma_f32_32x32x16_bf16 v[16:31], v[132:135], v[164:167], v[16:31]
s_waitcnt lgkmcnt(10)
v_mfma_f32_32x32x16_bf16 v[32:47], v[136:139], v[164:167], v[32:47]
s_waitcnt lgkmcnt(8)
v_mfma_f32_32x32x16_bf16 v[48:63], v[140:143], v[164:167], v[48:63]
s_sub_u32 s83, s83, 1
s_cbranch_scc0 L_loopA
s_waitcnt lgkmcnt(6)
v_mfma_f32_32x32x16_bf16 v[64:79], v[144:147], v[164:167], v[64:79]
s_waitcnt lgkmcnt(0)
s_barrier
v_add_u32 v232, 0x4000, v232
v_add_u32 v233, 0x4000, v233
v_add_u32 v234, 0x4000, v234
v_add_u32 v235, 0x4000, v235
v_xor_b32 v237, 64, v236
ds_read_b128 v[160:163], v237
ds_read_b64_tr_b16 v[128:129], v232 offset:0
ds_read_b64_tr_b16 v[130:131], v232 offset:2048
ds_read_b64_tr_b16 v[132:133], v233 offset:0
ds_read_b64_tr_b16 v[134:135], v233 offset:2048
s_waitcnt lgkmcnt(9)
v_mfma_f32_32x32x16_bf16 v[80:95], v[148:151], v[164:167], v[80:95]
ds_read_b64_tr_b16 v[136:137], v234 offset:0
ds_read_b64_tr_b16 v[138:139], v234 offset:2048
ds_read_b64_tr_b16 v[140:141], v235 offset:0
ds_read_b64_tr_b16 v[142:143], v235 offset:2048
s_waitcnt lgkmcnt(11)
v_mfma_f32_32x32x16_bf16 v[96:111], v[152:155], v[164:167], v[96:111]
ds_read_b64_tr_b16 v[144:145], v232 offset:256
ds_read_b64_tr_b16 v[146:147], v232 offset:2304
ds_read_b64_tr_b16 v[148:149], v233 offset:256
ds_read_b64_tr_b16 v[150:151], v233 offset:2304
s_waitcnt lgkmcnt(13)
v_mfma_f32_32x32x16_bf16 v[112:127], v[156:159], v[164:167], v[112:127]
ds_read_b64_tr_b16 v[152:153], v234 offset:256
ds_read_b64_tr_b16 v[154:155], v234 offset:2304
s_waitcnt lgkmcnt(12)
v_mfma_f32_32x32x16_bf16 v[0:15], v[128:131], v[160:163], v[0:15]
ds_read_b64_tr_b16 v[156:157], v235 offset:256
ds_read_b64_tr_b16 v[158:159], v235 offset:2304
s_waitcnt lgkmcnt(12)
v_mfma_f32_32x32x16_bf16 v[16:31], v[132:135], v[160:163], v[16:31]
v_xor_b32 v237, 96, v236
ds_read_b128 v[164:167], v237
ds_read_b64_tr_b16 v[128:129], v232 offset:8192
ds_read_b64_tr_b16 v[130:131], v232 offset:10240
s_waitcnt lgkmcnt(13)
v_mfma_f32_32x32x16_bf16 v[32:47], v[136:139], v[160:163], v[32:47]
ds_read_b64_tr_b16 v[132:133], v233 offset:8192
ds_read_b64_tr_b16 v[134:135], v233 offset:10240
s_waitcnt lgkmcnt(13)
v_mfma_f32_32x32x16_bf16 v[48:63], v[140:143], v[160:163], v[48:63]
ds_read_b64_tr_b16 v[136:137], v234 offset:8192
ds_read_b64_tr_b16 v[138:139], v234 offset:10240
s_waitcnt lgkmcnt(13)
v_mfma_f32_32x32x16_bf16 v[64:79], v[144:147], v[160:163], v[64:79]
ds_read_b64_tr_b16 v[140:141], v235 offset:8192
ds_read_b64_tr_b16 v[142:143], v235 offset:10240
s_waitcnt lgkmcnt(13)
v_mfma_f32_32x32x16_bf16 v[80:95], v[148:151], v[160:163], v[80:95]
ds_read_b64_tr_b16 v[144:145], v232 offset:8448
ds_read_b64_tr_b16 v[146:147], v232 offset:10496
s_waitcnt lgkmcnt(13)
v_mfma_f32_32x32x16_bf16 v[96:111], v[152:155], v[160:163], v[96:111]
ds_read_b64_tr_b16 v[148:149], v233 offset:8448
ds_read_b64_tr_b16 v[150:151], v233 offset:10496
s_waitcnt lgkmcnt(13)
v_mfma_f32_32x32x16_bf16 v[112:127], v[156:159], v[160:163], v[112:127]
ds_read_b64_tr_b16 v[152:153], v234 offset:8448
ds_read_b64_tr_b16 v[154:155], v234 offset:10496
s_waitcnt lgkmcnt(12)
v_mfma_f32_32x32x16_bf16 v[0:15], v[128:131], v[164:167], v[0:15]
ds_read_b64_tr_b16 v[156:157], v235 offset:8448
ds_read_b64_tr_b16 v[158:159], v235 offset:10496
s_waitcnt lgkmcnt(12)
v_mfma_f32_32x32x16_bf16 v[16:31], v[132:135], v[164:167], v[16:31]
s_waitcnt lgkmcnt(10)
v_mfma_f32_32x32x16_bf16 v[32:47], v[136:139], v[164:167], v[32:47]
s_waitcnt lgkmcnt(8)
v_mfma_f32_32x32x16_bf16 v[48:63], v[140:143], v[164:167], v[48:63]
s_waitcnt lgkmcnt(6)
v_mfma_f32_32x32x16_bf16 v[64:79], v[144:147], v[164:167], v[64:79]
s_nop 1
v_cvt_pk_bf16_f32 v0, v0, v1
v_cvt_pk_bf16_f32 v1, v2, v3
v_cvt_pk_bf16_f32 v2, v4, v5
v_cvt_pk_bf16_f32 v3, v6, v7
s_waitcnt lgkmcnt(0)
s_barrier
ds_read_b128 v[128:131], v238 offset:0
v_xor_b32 v237, 32, v238
ds_read_b128 v[132:135], v237 offset:0
s_waitcnt lgkmcnt(6)
v_mfma_f32_32x32x16_bf16 v[80:95], v[148:151], v[164:167], v[80:95]
v_cvt_pk_bf16_f32 v4, v8, v9
v_cvt_pk_bf16_f32 v5, v10, v11
v_cvt_pk_bf16_f32 v6, v12, v13
v_cvt_pk_bf16_f32 v7, v14, v15
v_xor_b32 v254, 64, v238
ds_read_b128 v[136:139], v254 offset:0
v_xor_b32 v237, 96, v238
ds_read_b128 v[140:143], v237 offset:0
s_waitcnt lgkmcnt(6)
v_mfma_f32_32x32x16_bf16 v[96:111], v[152:155], v[164:167], v[96:111]
v_cvt_pk_bf16_f32 v16, v16, v17
v_cvt_pk_bf16_f32 v17, v18, v19
v_cvt_pk_bf16_f32 v18, v20, v21
v_cvt_pk_bf16_f32 v19, v22, v23
v_xor_b32 v254, 128, v238
ds_read_b128 v[144:147], v254 offset:0
v_xor_b32 v237, 160, v238
ds_read_b128 v[148:151], v237 offset:0
s_waitcnt lgkmcnt(6)
v_mfma_f32_32x32x16_bf16 v[112:127], v[156:159], v[164:167], v[112:127]
v_cvt_pk_bf16_f32 v20, v24, v25
v_cvt_pk_bf16_f32 v21, v26, v27
v_cvt_pk_bf16_f32 v22, v28, v29
v_cvt_pk_bf16_f32 v23, v30, v31
v_xor_b32 v254, 192, v238
ds_read_b128 v[152:155], v254 offset:0
s_waitcnt lgkmcnt(6)
v_mfma_f32_32x32x16_bf16 v[168:183], v[128:131], v[0:3], 0
v_cvt_pk_bf16_f32 v32, v32, v33
v_cvt_pk_bf16_f32 v33, v34, v35
v_cvt_pk_bf16_f32 v34, v36, v37
v_cvt_pk_bf16_f32 v35, v38, v39
v_xor_b32 v237, 224, v238
ds_read_b128 v[156:159], v237 offset:0
s_waitcnt lgkmcnt(6)
v_mfma_f32_32x32x16_bf16 v[168:183], v[132:135], v[4:7], v[168:183]
v_cvt_pk_bf16_f32 v36, v40, v41
v_cvt_pk_bf16_f32 v37, v42, v43
v_cvt_pk_bf16_f32 v38, v44, v45
v_cvt_pk_bf16_f32 v39, v46, v47
ds_read_b128 v[128:131], v238 offset:256
s_waitcnt lgkmcnt(6)
v_mfma_f32_32x32x16_bf16 v[168:183], v[136:139], v[16:19], v[168:183]
v_cvt_pk_bf16_f32 v48, v48, v49
v_cvt_pk_bf16_f32 v49, v50, v51
v_cvt_pk_bf16_f32 v50, v52, v53
v_cvt_pk_bf16_f32 v51, v54, v55
v_xor_b32 v237, 32, v238
ds_read_b128 v[132:135], v237 offset:256
s_waitcnt lgkmcnt(6)
v_mfma_f32_32x32x16_bf16 v[168:183], v[140:143], v[20:23], v[168:183]
v_cvt_pk_bf16_f32 v52, v56, v57
v_cvt_pk_bf16_f32 v53, v58, v59
v_cvt_pk_bf16_f32 v54, v60, v61
v_cvt_pk_bf16_f32 v55, v62, v63
v_xor_b32 v254, 64, v238
ds_read_b128 v[136:139], v254 offset:256
s_waitcnt lgkmcnt(6)
v_mfma_f32_32x32x16_bf16 v[168:183], v[144:147], v[32:35], v[168:183]
v_cvt_pk_bf16_f32 v64, v64, v65
v_cvt_pk_bf16_f32 v65, v66, v67
v_cvt_pk_bf16_f32 v66, v68, v69
v_cvt_pk_bf16_f32 v67, v70, v71
v_xor_b32 v237, 96, v238
ds_read_b128 v[140:143], v237 offset:256
s_waitcnt lgkmcnt(6)
v_mfma_f32_32x32x16_bf16 v[168:183], v[148:151], v[36:39], v[168:183]
v_cvt_pk_bf16_f32 v68, v72, v73
v_cvt_pk_bf16_f32 v69, v74, v75
v_cvt_pk_bf16_f32 v70, v76, v77
v_cvt_pk_bf16_f32 v71, v78, v79
v_xor_b32 v254, 128, v238
ds_read_b128 v[144:147], v254 offset:256
s_waitcnt lgkmcnt(6)
v_mfma_f32_32x32x16_bf16 v[168:183], v[152:155], v[48:51], v[168:183]
v_cvt_pk_bf16_f32 v80, v80, v81
v_cvt_pk_bf16_f32 v81, v82, v83
v_cvt_pk_bf16_f32 v82, v84, v85
v_cvt_pk_bf16_f32 v83, v86, v87
v_xor_b32 v237, 160, v238
ds_read_b128 v[148:151], v237 offset:256
s_waitcnt lgkmcnt(6)
v_mfma_f32_32x32x16_bf16 v[168:183], v[156:159], v[52:55], v[168:183]
v_cvt_pk_bf16_f32 v84, v88, v89
v_cvt_pk_bf16_f32 v85, v90, v91
v_cvt_pk_bf16_f32 v86, v92, v93
v_cvt_pk_bf16_f32 v87, v94, v95
v_xor_b32 v254, 192, v238
ds_read_b128 v[152:155], v254 offset:256
s_waitcnt lgkmcnt(6)
v_mfma_f32_32x32x16_bf16 v[168:183], v[128:131], v[64:67], v[168:183]
v_cvt_pk_bf16_f32 v96, v96, v97
v_cvt_pk_bf16_f32 v97, v98, v99
v_cvt_pk_bf16_f32 v98, v100, v101
v_cvt_pk_bf16_f32 v99, v102, v103
v_xor_b32 v237, 224, v238
ds_read_b128 v[156:159], v237 offset:256
s_waitcnt lgkmcnt(6)
v_mfma_f32_32x32x16_bf16 v[168:183], v[132:135], v[68:71], v[168:183]
v_cvt_pk_bf16_f32 v100, v104, v105
v_cvt_pk_bf16_f32 v101, v106, v107
v_cvt_pk_bf16_f32 v102, v108, v109
v_cvt_pk_bf16_f32 v103, v110, v111
s_waitcnt lgkmcnt(5)
v_mfma_f32_32x32x16_bf16 v[168:183], v[136:139], v[80:83], v[168:183]
v_cvt_pk_bf16_f32 v112, v112, v113
v_cvt_pk_bf16_f32 v113, v114, v115
v_cvt_pk_bf16_f32 v114, v116, v117
v_cvt_pk_bf16_f32 v115, v118, v119
s_waitcnt lgkmcnt(4)
v_mfma_f32_32x32x16_bf16 v[168:183], v[140:143], v[84:87], v[168:183]
v_cvt_pk_bf16_f32 v116, v120, v121
v_cvt_pk_bf16_f32 v117, v122, v123
v_cvt_pk_bf16_f32 v118, v124, v125
v_cvt_pk_bf16_f32 v119, v126, v127
s_waitcnt lgkmcnt(3)
v_mfma_f32_32x32x16_bf16 v[168:183], v[144:147], v[96:99], v[168:183]
s_waitcnt lgkmcnt(0)
s_barrier
ds_read_b128 v[128:131], v239 offset:0
v_xor_b32 v237, 32, v239
ds_read_b128 v[132:135], v237 offset:0
s_waitcnt lgkmcnt(4)
v_mfma_f32_32x32x16_bf16 v[168:183], v[148:151], v[100:103], v[168:183]
v_xor_b32 v254, 64, v239
ds_read_b128 v[136:139], v254 offset:0
v_xor_b32 v237, 96, v239
ds_read_b128 v[140:143], v237 offset:0
s_waitcnt lgkmcnt(5)
v_mfma_f32_32x32x16_bf16 v[168:183], v[152:155], v[112:115], v[168:183]
v_xor_b32 v254, 128, v239
ds_read_b128 v[144:147], v254 offset:0
v_xor_b32 v237, 160, v239
ds_read_b128 v[148:151], v237 offset:0
s_waitcnt lgkmcnt(6)
v_mfma_f32_32x32x16_bf16 v[168:183], v[156:159], v[116:119], v[168:183]
v_xor_b32 v254, 192, v239
ds_read_b128 v[152:155], v254 offset:0
s_waitcnt lgkmcnt(6)
v_mfma_f32_32x32x16_bf16 v[184:199], v[128:131], v[0:3], 0
v_xor_b32 v237, 224, v239
ds_read_b128 v[156:159], v237 offset:0
s_waitcnt lgkmcnt(6)
v_mfma_f32_32x32x16_bf16 v[184:199], v[132:135], v[4:7], v[184:199]
ds_read_b128 v[128:131], v239 offset:256
s_waitcnt lgkmcnt(6)
v_mfma_f32_32x32x16_bf16 v[184:199], v[136:139], v[16:19], v[184:199]
v_xor_b32 v237, 32, v239
ds_read_b128 v[132:135], v237 offset:256
s_waitcnt lgkmcnt(6)
v_mfma_f32_32x32x16_bf16 v[184:199], v[140:143], v[20:23], v[184:199]
v_xor_b32 v254, 64, v239
ds_read_b128 v[136:139], v254 offset:256
s_waitcnt lgkmcnt(6)
v_mfma_f32_32x32x16_bf16 v[184:199], v[144:147], v[32:35], v[184:199]
v_xor_b32 v237, 96, v239
ds_read_b128 v[140:143], v237 offset:256
s_waitcnt lgkmcnt(6)
v_mfma_f32_32x32x16_bf16 v[184:199], v[148:151], v[36:39], v[184:199]
v_xor_b32 v254, 128, v239
ds_read_b128 v[144:147], v254 offset:256
s_waitcnt lgkmcnt(6)
v_mfma_f32_32x32x16_bf16 v[184:199], v[152:155], v[48:51], v[184:199]
v_xor_b32 v237, 160, v239
ds_read_b128 v[148:151], v237 offset:256
s_waitcnt lgkmcnt(6)
v_mfma_f32_32x32x16_bf16 v[184:199], v[156:159], v[52:55], v[184:199]
v_xor_b32 v254, 192, v239
ds_read_b128 v[152:155], v254 offset:256
s_waitcnt lgkmcnt(6)
v_mfma_f32_32x32x16_bf16 v[184:199], v[128:131], v[64:67], v[184:199]
v_xor_b32 v237, 224, v239
ds_read_b128 v[156:159], v237 offset:256
s_waitcnt lgkmcnt(6)
v_mfma_f32_32x32x16_bf16 v[184:199], v[132:135], v[68:71], v[184:199]
s_waitcnt lgkmcnt(5)
v_mfma_f32_32x32x16_bf16 v[184:199], v[136:139], v[80:83], v[184:199]
s_waitcnt lgkmcnt(4)
v_mfma_f32_32x32x16_bf16 v[184:199], v[140:143], v[84:87], v[184:199]
s_waitcnt lgkmcnt(3)
v_mfma_f32_32x32x16_bf16 v[184:199], v[144:147], v[96:99], v[184:199]
s_waitcnt lgkmcnt(2)
v_mfma_f32_32x32x16_bf16 v[184:199], v[148:151], v[100:103], v[184:199]
s_waitcnt lgkmcnt(1)
v_mfma_f32_32x32x16_bf16 v[184:199], v[152:155], v[112:115], v[184:199]
s_waitcnt lgkmcnt(0)
v_mfma_f32_32x32x16_bf16 v[184:199], v[156:159], v[116:119], v[184:199]
s_waitcnt lgkmcnt(0)
s_barrier
ds_read_b64_tr_b16 v[128:129], v240 offset:0
ds_read_b64_tr_b16 v[130:131], v240 offset:4096
ds_read_b64_tr_b16 v[132:133], v240 offset:8192
ds_read_b64_tr_b16 v[134:135], v240 offset:12288
ds_read_b64_tr_b16 v[136:137], v241 offset:0
ds_read_b64_tr_b16 v[138:139], v241 offset:4096
ds_read_b64_tr_b16 v[140:141], v241 offset:8192
ds_read_b64_tr_b16 v[142:143], v241 offset:12288
ds_read_b64_tr_b16 v[144:145], v242 offset:0
ds_read_b64_tr_b16 v[146:147], v242 offset:4096
ds_read_b64_tr_b16 v[148:149], v242 offset:8192
ds_read_b64_tr_b16 v[150:151], v242 offset:12288
ds_read_b64_tr_b16 v[152:153], v243 offset:0
ds_read_b64_tr_b16 v[154:155], v243 offset:4096
v_max3_f32 v252, v168, v169, v170
v_max3_f32 v253, v171, v172, v173
v_max3_f32 v252, v252, v174, v175
v_max3_f32 v253, v253, v176, v177
v_max3_f32 v252, v252, v178, v179
v_max3_f32 v253, v253, v180, v181
v_max3_f32 v252, v252, v182, v183
v_max3_f32 v253, v253, v184, v185
v_max3_f32 v252, v252, v186, v187
v_max3_f32 v253, v253, v188, v189
v_max3_f32 v252, v252, v190, v191
v_max3_f32 v253, v253, v192, v193
v_max3_f32 v252, v252, v194, v195
v_max3_f32 v253, v253, v196, v197
v_max3_f32 v252, v252, v198, v199
v_max_f32 v252, v252, v253
v_mov_b32 v253, v252
s_nop 1
v_permlane32_swap_b32 v253, v252
s_nop 0
v_max_f32 v252, v252, v253
v_mul_f32 v252, s54, v252
v_mov_b32 v253, v252
v_pk_fma_f32 v[168:169], v[168:169], s[58:59], v[252:253] neg_lo:[0,0,1] neg_hi:[0,0,1]
v_pk_fma_f32 v[170:171], v[170:171], s[58:59], v[252:253] neg_lo:[0,0,1] neg_hi:[0,0,1]
v_pk_fma_f32 v[172:173], v[172:173], s[58:59], v[252:253] neg_lo:[0,0,1] neg_hi:[0,0,1]
v_pk_fma_f32 v[174:175], v[174:175], s[58:59], v[252:253] neg_lo:[0,0,1] neg_hi:[0,0,1]
v_pk_fma_f32 v[176:177], v[176:177], s[58:59], v[252:253] neg_lo:[0,0,1] neg_hi:[0,0,1]
v_pk_fma_f32 v[178:179], v[178:179], s[58:59], v[252:253] neg_lo:[0,0,1] neg_hi:[0,0,1]
v_pk_fma_f32 v[180:181], v[180:181], s[58:59], v[252:253] neg_lo:[0,0,1] neg_hi:[0,0,1]
v_pk_fma_f32 v[182:183], v[182:183], s[58:59], v[252:253] neg_lo:[0,0,1] neg_hi:[0,0,1]
v_pk_fma_f32 v[184:185], v[184:185], s[58:59], v[252:253] neg_lo:[0,0,1] neg_hi:[0,0,1]
v_pk_fma_f32 v[186:187], v[186:187], s[58:59], v[252:253] neg_lo:[0,0,1] neg_hi:[0,0,1]
v_pk_fma_f32 v[188:189], v[188:189], s[58:59], v[252:253] neg_lo:[0,0,1] neg_hi:[0,0,1]
v_pk_fma_f32 v[190:191], v[190:191], s[58:59], v[252:253] neg_lo:[0,0,1] neg_hi:[0,0,1]
v_pk_fma_f32 v[192:193], v[192:193], s[58:59], v[252:253] neg_lo:[0,0,1] neg_hi:[0,0,1]
v_pk_fma_f32 v[194:195], v[194:195], s[58:59], v[252:253] neg_lo:[0,0,1] neg_hi:[0,0,1]
v_pk_fma_f32 v[196:197], v[196:197], s[58:59], v[252:253] neg_lo:[0,0,1] neg_hi:[0,0,1]
v_pk_fma_f32 v[198:199], v[198:199], s[58:59], v[252:253] neg_lo:[0,0,1] neg_hi:[0,0,1]
v_exp_f32 v168, v168
v_exp_f32 v169, v169
v_exp_f32 v170, v170
v_exp_f32 v171, v171
v_exp_f32 v172, v172
v_pk_add_f32 v[252:253], v[168:169], v[170:171]
v_exp_f32 v173, v173
v_exp_f32 v174, v174
v_pk_add_f32 v[252:253], v[252:253], v[172:173]
v_exp_f32 v175, v175
v_exp_f32 v176, v176
v_pk_add_f32 v[252:253], v[252:253], v[174:175]
v_exp_f32 v177, v177
v_exp_f32 v178, v178
v_pk_add_f32 v[252:253], v[252:253], v[176:177]
v_exp_f32 v179, v179
v_exp_f32 v180, v180
v_pk_add_f32 v[252:253], v[252:253], v[178:179]
v_exp_f32 v181, v181
v_exp_f32 v182, v182
v_pk_add_f32 v[252:253], v[252:253], v[180:181]
v_exp_f32 v183, v183
v_exp_f32 v184, v184
v_pk_add_f32 v[252:253], v[252:253], v[182:183]
v_exp_f32 v185, v185
v_exp_f32 v186, v186
v_pk_add_f32 v[252:253], v[252:253], v[184:185]
v_exp_f32 v187, v187
v_exp_f32 v188, v188
v_pk_add_f32 v[252:253], v[252:253], v[186:187]
v_exp_f32 v189, v189
v_exp_f32 v190, v190
v_pk_add_f32 v[252:253], v[252:253], v[188:189]
v_exp_f32 v191, v191
v_exp_f32 v192, v192
v_pk_add_f32 v[252:253], v[252:253], v[190:191]
v_exp_f32 v193, v193
v_exp_f32 v194, v194
v_pk_add_f32 v[252:253], v[252:253], v[192:193]
v_exp_f32 v195, v195
v_exp_f32 v196, v196
v_pk_add_f32 v[252:253], v[252:253], v[194:195]
v_exp_f32 v197, v197
v_exp_f32 v198, v198
v_pk_add_f32 v[252:253], v[252:253], v[196:197]
v_exp_f32 v199, v199
s_nop 0
v_pk_add_f32 v[252:253], v[252:253], v[198:199]
v_add_f32 v252, v252, v253
v_mov_b32 v253, v252
s_nop 1
v_permlane32_swap_b32 v253, v252
s_nop 0
v_add_f32 v252, v252, v253
v_rcp_f32 v252, v252
s_nop 0
v_mov_b32 v253, v252
v_pk_mul_f32 v[168:169], v[168:169], v[252:253]
v_pk_mul_f32 v[170:171], v[170:171], v[252:253]
v_cvt_pk_bf16_f32 v200, v168, v169
v_pk_mul_f32 v[172:173], v[172:173], v[252:253]
v_cvt_pk_bf16_f32 v201, v170, v171
v_pk_mul_f32 v[174:175], v[174:175], v[252:253]
v_cvt_pk_bf16_f32 v202, v172, v173
v_pk_mul_f32 v[176:177], v[176:177], v[252:253]
v_cvt_pk_bf16_f32 v203, v174, v175
v_pk_mul_f32 v[178:179], v[178:179], v[252:253]
v_cvt_pk_bf16_f32 v204, v176, v177
v_pk_mul_f32 v[180:181], v[180:181], v[252:253]
v_cvt_pk_bf16_f32 v205, v178, v179
v_pk_mul_f32 v[182:183], v[182:183], v[252:253]
v_cvt_pk_bf16_f32 v206, v180, v181
v_pk_mul_f32 v[184:185], v[184:185], v[252:253]
v_cvt_pk_bf16_f32 v207, v182, v183
v_pk_mul_f32 v[186:187], v[186:187], v[252:253]
v_cvt_pk_bf16_f32 v208, v184, v185
v_pk_mul_f32 v[188:189], v[188:189], v[252:253]
v_cvt_pk_bf16_f32 v209, v186, v187
v_pk_mul_f32 v[190:191], v[190:191], v[252:253]
v_cvt_pk_bf16_f32 v210, v188, v189
v_pk_mul_f32 v[192:193], v[192:193], v[252:253]
v_cvt_pk_bf16_f32 v211, v190, v191
v_pk_mul_f32 v[194:195], v[194:195], v[252:253]
v_cvt_pk_bf16_f32 v212, v192, v193
v_pk_mul_f32 v[196:197], v[196:197], v[252:253]
v_cvt_pk_bf16_f32 v213, v194, v195
v_pk_mul_f32 v[198:199], v[198:199], v[252:253]
v_cvt_pk_bf16_f32 v214, v196, v197
v_cvt_pk_bf16_f32 v215, v198, v199
s_waitcnt lgkmcnt(12)
v_mfma_f32_32x32x16_bf16 v[0:15], v[128:131], v[200:203], 0
ds_read_b64_tr_b16 v[156:157], v243 offset:8192
ds_read_b64_tr_b16 v[158:159], v243 offset:12288
s_waitcnt lgkmcnt(12)
v_mfma_f32_32x32x16_bf16 v[0:15], v[132:135], v[204:207], v[0:15]
ds_read_b64_tr_b16 v[128:129], v240 offset:256
ds_read_b64_tr_b16 v[130:131], v240 offset:4352
s_waitcnt lgkmcnt(12)
v_mfma_f32_32x32x16_bf16 v[16:31], v[136:139], v[200:203], 0
ds_read_b64_tr_b16 v[132:133], v240 offset:8448
ds_read_b64_tr_b16 v[134:135], v240 offset:12544
s_waitcnt lgkmcnt(12)
v_mfma_f32_32x32x16_bf16 v[16:31], v[140:143], v[204:207], v[16:31]
ds_read_b64_tr_b16 v[136:137], v241 offset:256
ds_read_b64_tr_b16 v[138:139], v241 offset:4352
s_waitcnt lgkmcnt(12)
v_mfma_f32_32x32x16_bf16 v[32:47], v[144:147], v[200:203], 0
ds_read_b64_tr_b16 v[140:141], v241 offset:8448
ds_read_b64_tr_b16 v[142:143], v241 offset:12544
s_waitcnt lgkmcnt(12)
v_mfma_f32_32x32x16_bf16 v[32:47], v[148:151], v[204:207], v[32:47]
ds_read_b64_tr_b16 v[144:145], v242 offset:256
ds_read_b64_tr_b16 v[146:147], v242 offset:4352
s_waitcnt lgkmcnt(12)
v_mfma_f32_32x32x16_bf16 v[48:63], v[152:155], v[200:203], 0
ds_read_b64_tr_b16 v[148:149], v242 offset:8448
ds_read_b64_tr_b16 v[150:151], v242 offset:12544
s_waitcnt lgkmcnt(12)
v_mfma_f32_32x32x16_bf16 v[48:63], v[156:159], v[204:207], v[48:63]
ds_read_b64_tr_b16 v[152:153], v243 offset:256
ds_read_b64_tr_b16 v[154:155], v243 offset:4352
s_waitcnt lgkmcnt(12)
v_mfma_f32_32x32x16_bf16 v[64:79], v[128:131], v[200:203], 0
ds_read_b64_tr_b16 v[156:157], v243 offset:8448
ds_read_b64_tr_b16 v[158:159], v243 offset:12544
s_waitcnt lgkmcnt(12)
v_mfma_f32_32x32x16_bf16 v[64:79], v[132:135], v[204:207], v[64:79]
s_waitcnt lgkmcnt(10)
v_mfma_f32_32x32x16_bf16 v[80:95], v[136:139], v[200:203], 0
s_waitcnt lgkmcnt(8)
v_mfma_f32_32x32x16_bf16 v[80:95], v[140:143], v[204:207], v[80:95]
s_waitcnt lgkmcnt(6)
v_mfma_f32_32x32x16_bf16 v[96:111], v[144:147], v[200:203], 0
s_waitcnt lgkmcnt(0)
s_barrier
ds_read_b64_tr_b16 v[128:129], v244 offset:0
ds_read_b64_tr_b16 v[130:131], v244 offset:4096
ds_read_b64_tr_b16 v[132:133], v244 offset:8192
ds_read_b64_tr_b16 v[134:135], v244 offset:12288
s_waitcnt lgkmcnt(8)
v_mfma_f32_32x32x16_bf16 v[96:111], v[148:151], v[204:207], v[96:111]
ds_read_b64_tr_b16 v[136:137], v245 offset:0
ds_read_b64_tr_b16 v[138:139], v245 offset:4096
ds_read_b64_tr_b16 v[140:141], v245 offset:8192
ds_read_b64_tr_b16 v[142:143], v245 offset:12288
s_waitcnt lgkmcnt(10)
v_mfma_f32_32x32x16_bf16 v[112:127], v[152:155], v[200:203], 0
ds_read_b64_tr_b16 v[144:145], v246 offset:0
ds_read_b64_tr_b16 v[146:147], v246 offset:4096
ds_read_b64_tr_b16 v[148:149], v246 offset:8192
ds_read_b64_tr_b16 v[150:151], v246 offset:12288
s_waitcnt lgkmcnt(12)
v_mfma_f32_32x32x16_bf16 v[112:127], v[156:159], v[204:207], v[112:127]
ds_read_b64_tr_b16 v[152:153], v247 offset:0
ds_read_b64_tr_b16 v[154:155], v247 offset:4096
s_waitcnt lgkmcnt(12)
v_mfma_f32_32x32x16_bf16 v[0:15], v[128:131], v[208:211], v[0:15]
ds_read_b64_tr_b16 v[156:157], v247 offset:8192
ds_read_b64_tr_b16 v[158:159], v247 offset:12288
s_waitcnt lgkmcnt(12)
v_mfma_f32_32x32x16_bf16 v[0:15], v[132:135], v[212:215], v[0:15]
ds_read_b64_tr_b16 v[128:129], v244 offset:256
ds_read_b64_tr_b16 v[130:131], v244 offset:4352
s_waitcnt lgkmcnt(12)
v_mfma_f32_32x32x16_bf16 v[16:31], v[136:139], v[208:211], v[16:31]
ds_read_b64_tr_b16 v[132:133], v244 offset:8448
ds_read_b64_tr_b16 v[134:135], v244 offset:12544
s_waitcnt lgkmcnt(12)
v_mfma_f32_32x32x16_bf16 v[16:31], v[140:143], v[212:215], v[16:31]
ds_read_b64_tr_b16 v[136:137], v245 offset:256
ds_read_b64_tr_b16 v[138:139], v245 offset:4352
s_waitcnt lgkmcnt(12)
v_mfma_f32_32x32x16_bf16 v[32:47], v[144:147], v[208:211], v[32:47]
ds_read_b64_tr_b16 v[140:141], v245 offset:8448
ds_read_b64_tr_b16 v[142:143], v245 offset:12544
s_waitcnt lgkmcnt(12)
v_mfma_f32_32x32x16_bf16 v[32:47], v[148:151], v[212:215], v[32:47]
v_cvt_pk_bf16_f32 v0, v0, v1
v_cvt_pk_bf16_f32 v1, v2, v3
v_cvt_pk_bf16_f32 v2, v4, v5
ds_read_b64_tr_b16 v[144:145], v246 offset:256
ds_read_b64_tr_b16 v[146:147], v246 offset:4352
s_waitcnt lgkmcnt(12)
v_mfma_f32_32x32x16_bf16 v[48:63], v[152:155], v[208:211], v[48:63]
v_cvt_pk_bf16_f32 v3, v6, v7
v_cvt_pk_bf16_f32 v4, v8, v9
v_cvt_pk_bf16_f32 v5, v10, v11
ds_read_b64_tr_b16 v[148:149], v246 offset:8448
ds_read_b64_tr_b16 v[150:151], v246 offset:12544
s_waitcnt lgkmcnt(12)
v_mfma_f32_32x32x16_bf16 v[48:63], v[156:159], v[212:215], v[48:63]
v_cvt_pk_bf16_f32 v6, v12, v13
v_cvt_pk_bf16_f32 v7, v14, v15
v_cvt_pk_bf16_f32 v16, v16, v17
ds_read_b64_tr_b16 v[152:153], v247 offset:256
ds_read_b64_tr_b16 v[154:155], v247 offset:4352
s_waitcnt lgkmcnt(12)
v_mfma_f32_32x32x16_bf16 v[64:79], v[128:131], v[208:211], v[64:79]
v_cvt_pk_bf16_f32 v17, v18, v19
v_cvt_pk_bf16_f32 v18, v20, v21
v_cvt_pk_bf16_f32 v19, v22, v23
ds_read_b64_tr_b16 v[156:157], v247 offset:8448
ds_read_b64_tr_b16 v[158:159], v247 offset:12544
s_waitcnt lgkmcnt(12)
v_mfma_f32_32x32x16_bf16 v[64:79], v[132:135], v[212:215], v[64:79]
v_cvt_pk_bf16_f32 v20, v24, v25
v_cvt_pk_bf16_f32 v21, v26, v27
v_cvt_pk_bf16_f32 v22, v28, v29
s_waitcnt lgkmcnt(10)
v_mfma_f32_32x32x16_bf16 v[80:95], v[136:139], v[208:211], v[80:95]
v_cvt_pk_bf16_f32 v23, v30, v31
v_cvt_pk_bf16_f32 v32, v32, v33
v_cvt_pk_bf16_f32 v33, v34, v35
s_waitcnt lgkmcnt(8)
v_mfma_f32_32x32x16_bf16 v[80:95], v[140:143], v[212:215], v[80:95]
v_cvt_pk_bf16_f32 v34, v36, v37
v_cvt_pk_bf16_f32 v35, v38, v39
v_cvt_pk_bf16_f32 v36, v40, v41
s_waitcnt lgkmcnt(6)
v_mfma_f32_32x32x16_bf16 v[96:111], v[144:147], v[208:211], v[96:111]
v_cvt_pk_bf16_f32 v37, v42, v43
v_cvt_pk_bf16_f32 v38, v44, v45
v_cvt_pk_bf16_f32 v39, v46, v47
s_waitcnt lgkmcnt(0)
s_barrier
ds_read_b64_tr_b16 v[128:129], v248 offset:0
ds_read_b64_tr_b16 v[130:131], v248 offset:1024
ds_read_b64_tr_b16 v[132:133], v249 offset:0
ds_read_b64_tr_b16 v[134:135], v249 offset:1024
s_waitcnt lgkmcnt(8)
v_mfma_f32_32x32x16_bf16 v[96:111], v[148:151], v[212:215], v[96:111]
v_cvt_pk_bf16_f32 v48, v48, v49
v_cvt_pk_bf16_f32 v49, v50, v51
v_cvt_pk_bf16_f32 v50, v52, v53
ds_read_b64_tr_b16 v[136:137], v248 offset:2048
ds_read_b64_tr_b16 v[138:139], v248 offset:3072
ds_read_b64_tr_b16 v[140:141], v249 offset:2048
ds_read_b64_tr_b16 v[142:143], v249 offset:3072
s_waitcnt lgkmcnt(10)
v_mfma_f32_32x32x16_bf16 v[112:127], v[152:155], v[208:211], v[112:127]
v_cvt_pk_bf16_f32 v51, v54, v55
v_cvt_pk_bf16_f32 v52, v56, v57
v_cvt_pk_bf16_f32 v53, v58, v59
ds_read_b64_tr_b16 v[144:145], v248 offset:4096
ds_read_b64_tr_b16 v[146:147], v248 offset:5120
ds_read_b64_tr_b16 v[148:149], v249 offset:4096
ds_read_b64_tr_b16 v[150:151], v249 offset:5120
s_waitcnt lgkmcnt(12)
v_mfma_f32_32x32x16_bf16 v[112:127], v[156:159], v[212:215], v[112:127]
v_cvt_pk_bf16_f32 v54, v60, v61
v_cvt_pk_bf16_f32 v55, v62, v63
v_cvt_pk_bf16_f32 v64, v64, v65
ds_read_b64_tr_b16 v[152:153], v248 offset:6144
ds_read_b64_tr_b16 v[154:155], v248 offset:7168
s_waitcnt lgkmcnt(12)
v_mfma_f32_32x32x16_bf16 v[168:183], v[128:131], v[0:3], 0
v_cvt_pk_bf16_f32 v65, v66, v67
v_cvt_pk_bf16_f32 v66, v68, v69
v_cvt_pk_bf16_f32 v67, v70, v71
ds_read_b64_tr_b16 v[156:157], v249 offset:6144
ds_read_b64_tr_b16 v[158:159], v249 offset:7168
s_waitcnt lgkmcnt(12)
v_mfma_f32_32x32x16_bf16 v[184:199], v[132:135], v[0:3], 0
v_cvt_pk_bf16_f32 v68, v72, v73
v_cvt_pk_bf16_f32 v69, v74, v75
v_cvt_pk_bf16_f32 v70, v76, v77
s_mov_b32 s48, 0x59832764
s_mov_b32 s49, 0x76410
v_subrev_u32 v232, 16384, v248
v_subrev_u32 v233, 16384, v249
ds_read_b64_tr_b16 v[128:129], v248 offset:8192
ds_read_b64_tr_b16 v[130:131], v248 offset:9216
s_waitcnt lgkmcnt(12)
v_mfma_f32_32x32x16_bf16 v[168:183], v[136:139], v[4:7], v[168:183]
v_cvt_pk_bf16_f32 v71, v78, v79
v_cvt_pk_bf16_f32 v80, v80, v81
v_cvt_pk_bf16_f32 v81, v82, v83
v_mov_b32 v252, s78
ds_read_b64_tr_b16 v[132:133], v249 offset:8192
ds_read_b64_tr_b16 v[134:135], v249 offset:9216
s_waitcnt lgkmcnt(12)
v_mfma_f32_32x32x16_bf16 v[184:199], v[140:143], v[4:7], v[184:199]
v_cvt_pk_bf16_f32 v82, v84, v85
v_cvt_pk_bf16_f32 v83, v86, v87
v_cvt_pk_bf16_f32 v84, v88, v89
v_bfrev_b32 v237, 1
s_sub_u32 s57, s57, 512
ds_read_b64_tr_b16 v[136:137], v248 offset:10240
ds_read_b64_tr_b16 v[138:139], v248 offset:11264
s_waitcnt lgkmcnt(12)
v_mfma_f32_32x32x16_bf16 v[168:183], v[144:147], v[16:19], v[168:183]
v_cvt_pk_bf16_f32 v85, v90, v91
v_cvt_pk_bf16_f32 v86, v92, v93
v_cvt_pk_bf16_f32 v87, v94, v95
v_bfe_u32 v236, v250, 4, 2
s_lshl_b32 s46, s81, 2
s_add_u32 s46, s46, s44
s_lshl_b32 s46, s46, 2
buffer_load_ubyte v253, v236, s[88:91], s46 offen sc1
v_bfe_u32 v238, v250, 4, 4
s_andn2_b32 s46, s80, 15
buffer_load_ubyte v255, v238, s[88:91], s46 offen sc1
ds_read_b64_tr_b16 v[140:141], v249 offset:10240
ds_read_b64_tr_b16 v[142:143], v249 offset:11264
s_waitcnt lgkmcnt(12)
v_mfma_f32_32x32x16_bf16 v[184:199], v[148:151], v[16:19], v[184:199]
v_cvt_pk_bf16_f32 v96, v96, v97
v_cvt_pk_bf16_f32 v97, v98, v99
v_cvt_pk_bf16_f32 v98, v100, v101
ds_read_b64_tr_b16 v[144:145], v248 offset:12288
ds_read_b64_tr_b16 v[146:147], v248 offset:13312
s_waitcnt lgkmcnt(12)
v_mfma_f32_32x32x16_bf16 v[168:183], v[152:155], v[20:23], v[168:183]
v_cvt_pk_bf16_f32 v99, v102, v103
v_cvt_pk_bf16_f32 v100, v104, v105
v_cvt_pk_bf16_f32 v101, v106, v107
ds_read_b64_tr_b16 v[148:149], v249 offset:12288
ds_read_b64_tr_b16 v[150:151], v249 offset:13312
s_waitcnt lgkmcnt(12)
v_mfma_f32_32x32x16_bf16 v[184:199], v[156:159], v[20:23], v[184:199]
v_cvt_pk_bf16_f32 v102, v108, v109
v_cvt_pk_bf16_f32 v103, v110, v111
v_cvt_pk_bf16_f32 v112, v112, v113
ds_read_b64_tr_b16 v[152:153], v248 offset:14336
ds_read_b64_tr_b16 v[154:155], v248 offset:15360
s_waitcnt lgkmcnt(12)
v_mfma_f32_32x32x16_bf16 v[168:183], v[128:131], v[32:35], v[168:183]
v_cvt_pk_bf16_f32 v113, v114, v115
v_cvt_pk_bf16_f32 v114, v116, v117
v_cvt_pk_bf16_f32 v115, v118, v119
ds_read_b64_tr_b16 v[156:157], v249 offset:14336
ds_read_b64_tr_b16 v[158:159], v249 offset:15360
s_waitcnt lgkmcnt(12)
v_mfma_f32_32x32x16_bf16 v[184:199], v[132:135], v[32:35], v[184:199]
v_cvt_pk_bf16_f32 v116, v120, v121
v_cvt_pk_bf16_f32 v117, v122, v123
v_cvt_pk_bf16_f32 v118, v124, v125
s_and_b32 s47, s48, 15
s_lshr_b64 s[48:49], s[48:49], 4
s_lshl_b32 s47, s47, 14
v_add_u32 v248, s47, v232
v_add_u32 v249, s47, v233
ds_read_b64_tr_b16 v[128:129], v248 offset:0
ds_read_b64_tr_b16 v[130:131], v248 offset:1024
s_waitcnt lgkmcnt(12)
v_mfma_f32_32x32x16_bf16 v[168:183], v[136:139], v[36:39], v[168:183]
v_cvt_pk_bf16_f32 v119, v126, v127
ds_read_b64_tr_b16 v[132:133], v249 offset:0
ds_read_b64_tr_b16 v[134:135], v249 offset:1024
s_waitcnt lgkmcnt(12)
v_mfma_f32_32x32x16_bf16 v[184:199], v[140:143], v[36:39], v[184:199]
ds_read_b64_tr_b16 v[136:137], v248 offset:2048
ds_read_b64_tr_b16 v[138:139], v248 offset:3072
s_waitcnt lgkmcnt(12)
v_mfma_f32_32x32x16_bf16 v[168:183], v[144:147], v[48:51], v[168:183]
ds_read_b64_tr_b16 v[140:141], v249 offset:2048
ds_read_b64_tr_b16 v[142:143], v249 offset:3072
s_waitcnt lgkmcnt(12)
v_mfma_f32_32x32x16_bf16 v[184:199], v[148:151], v[48:51], v[184:199]
ds_read_b64_tr_b16 v[144:145], v248 offset:4096
ds_read_b64_tr_b16 v[146:147], v248 offset:5120
s_waitcnt lgkmcnt(12)
v_mfma_f32_32x32x16_bf16 v[168:183], v[152:155], v[52:55], v[168:183]
ds_read_b64_tr_b16 v[148:149], v249 offset:4096
ds_read_b64_tr_b16 v[150:151], v249 offset:5120
s_waitcnt lgkmcnt(12)
v_mfma_f32_32x32x16_bf16 v[184:199], v[156:159], v[52:55], v[184:199]
ds_read_b64_tr_b16 v[152:153], v248 offset:6144
ds_read_b64_tr_b16 v[154:155], v248 offset:7168
s_waitcnt lgkmcnt(12)
v_mfma_f32_32x32x16_bf16 v[168:183], v[128:131], v[64:67], v[168:183]
ds_read_b64_tr_b16 v[156:157], v249 offset:6144
ds_read_b64_tr_b16 v[158:159], v249 offset:7168
s_waitcnt lgkmcnt(12)
v_mfma_f32_32x32x16_bf16 v[184:199], v[132:135], v[64:67], v[184:199]
ds_read_b64_tr_b16 v[128:129], v248 offset:8192
ds_read_b64_tr_b16 v[130:131], v248 offset:9216
s_waitcnt lgkmcnt(12)
v_mfma_f32_32x32x16_bf16 v[168:183], v[136:139], v[68:71], v[168:183]
ds_read_b64_tr_b16 v[132:133], v249 offset:8192
ds_read_b64_tr_b16 v[134:135], v249 offset:9216
s_waitcnt lgkmcnt(12)
v_mfma_f32_32x32x16_bf16 v[184:199], v[140:143], v[68:71], v[184:199]
ds_read_b64_tr_b16 v[136:137], v248 offset:10240
ds_read_b64_tr_b16 v[138:139], v248 offset:11264
s_waitcnt lgkmcnt(12)
v_mfma_f32_32x32x16_bf16 v[168:183], v[144:147], v[80:83], v[168:183]
ds_read_b64_tr_b16 v[140:141], v249 offset:10240
ds_read_b64_tr_b16 v[142:143], v249 offset:11264
s_waitcnt lgkmcnt(12)
v_mfma_f32_32x32x16_bf16 v[184:199], v[148:151], v[80:83], v[184:199]
ds_read_b64_tr_b16 v[144:145], v248 offset:12288
ds_read_b64_tr_b16 v[146:147], v248 offset:13312
s_waitcnt lgkmcnt(12)
v_mfma_f32_32x32x16_bf16 v[168:183], v[152:155], v[84:87], v[168:183]
ds_read_b64_tr_b16 v[148:149], v249 offset:12288
ds_read_b64_tr_b16 v[150:151], v249 offset:13312
s_waitcnt lgkmcnt(12)
v_mfma_f32_32x32x16_bf16 v[184:199], v[156:159], v[84:87], v[184:199]
ds_read_b64_tr_b16 v[152:153], v248 offset:14336
ds_read_b64_tr_b16 v[154:155], v248 offset:15360
s_waitcnt lgkmcnt(12)
v_mfma_f32_32x32x16_bf16 v[168:183], v[128:131], v[96:99], v[168:183]
ds_read_b64_tr_b16 v[156:157], v249 offset:14336
ds_read_b64_tr_b16 v[158:159], v249 offset:15360
s_waitcnt lgkmcnt(12)
v_mfma_f32_32x32x16_bf16 v[184:199], v[132:135], v[96:99], v[184:199]
s_waitcnt lgkmcnt(10)
v_mfma_f32_32x32x16_bf16 v[168:183], v[136:139], v[100:103], v[168:183]
s_waitcnt lgkmcnt(8)
v_mfma_f32_32x32x16_bf16 v[184:199], v[140:143], v[100:103], v[184:199]
s_mov_b32 s50, 2
L_loopB:
s_waitcnt lgkmcnt(6)
v_mfma_f32_32x32x16_bf16 v[168:183], v[144:147], v[112:115], v[168:183]
s_waitcnt lgkmcnt(0)
s_barrier
s_and_b32 s47, s48, 15
s_lshr_b64 s[48:49], s[48:49], 4
s_lshl_b32 s47, s47, 14
v_add_u32 v248, s47, v232
v_add_u32 v249, s47, v233
ds_read_b64_tr_b16 v[128:129], v248 offset:0
ds_read_b64_tr_b16 v[130:131], v248 offset:1024
ds_read_b64_tr_b16 v[132:133], v249 offset:0
ds_read_b64_tr_b16 v[134:135], v249 offset:1024
s_waitcnt lgkmcnt(8)
v_mfma_f32_32x32x16_bf16 v[184:199], v[148:151], v[112:115], v[184:199]
ds_read_b64_tr_b16 v[136:137], v248 offset:2048
ds_read_b64_tr_b16 v[138:139], v248 offset:3072
ds_read_b64_tr_b16 v[140:141], v249 offset:2048
ds_read_b64_tr_b16 v[142:143], v249 offset:3072
s_waitcnt lgkmcnt(10)
v_mfma_f32_32x32x16_bf16 v[168:183], v[152:155], v[116:119], v[168:183]
ds_read_b64_tr_b16 v[144:145], v248 offset:4096
ds_read_b64_tr_b16 v[146:147], v248 offset:5120
ds_read_b64_tr_b16 v[148:149], v249 offset:4096
ds_read_b64_tr_b16 v[150:151], v249 offset:5120
s_waitcnt lgkmcnt(12)
v_mfma_f32_32x32x16_bf16 v[184:199], v[156:159], v[116:119], v[184:199]
ds_read_b64_tr_b16 v[152:153], v248 offset:6144
ds_read_b64_tr_b16 v[154:155], v248 offset:7168
s_waitcnt lgkmcnt(12)
v_mfma_f32_32x32x16_bf16 v[200:215], v[128:131], v[0:3], 0
ds_read_b64_tr_b16 v[156:157], v249 offset:6144
ds_read_b64_tr_b16 v[158:159], v249 offset:7168
s_waitcnt lgkmcnt(12)
v_mfma_f32_32x32x16_bf16 v[216:231], v[132:135], v[0:3], 0
ds_read_b64_tr_b16 v[128:129], v248 offset:8192
ds_read_b64_tr_b16 v[130:131], v248 offset:9216
s_waitcnt lgkmcnt(12)
v_mfma_f32_32x32x16_bf16 v[200:215], v[136:139], v[4:7], v[200:215]
ds_read_b64_tr_b16 v[132:133], v249 offset:8192
ds_read_b64_tr_b16 v[134:135], v249 offset:9216
s_waitcnt lgkmcnt(12)
v_mfma_f32_32x32x16_bf16 v[216:231], v[140:143], v[4:7], v[216:231]
ds_read_b64_tr_b16 v[136:137], v248 offset:10240
ds_read_b64_tr_b16 v[138:139], v248 offset:11264
s_waitcnt lgkmcnt(12)
v_mfma_f32_32x32x16_bf16 v[200:215], v[144:147], v[16:19], v[200:215]
ds_read_b64_tr_b16 v[140:141], v249 offset:10240
ds_read_b64_tr_b16 v[142:143], v249 offset:11264
s_waitcnt lgkmcnt(12)
v_mfma_f32_32x32x16_bf16 v[216:231], v[148:151], v[16:19], v[216:231]
v_cvt_pk_bf16_f32 v168, v168, v169
ds_read_b64_tr_b16 v[144:145], v248 offset:12288
ds_read_b64_tr_b16 v[146:147], v248 offset:13312
s_waitcnt lgkmcnt(12)
v_mfma_f32_32x32x16_bf16 v[200:215], v[152:155], v[20:23], v[200:215]
v_cvt_pk_bf16_f32 v169, v170, v171
ds_read_b64_tr_b16 v[148:149], v249 offset:12288
ds_read_b64_tr_b16 v[150:151], v249 offset:13312
s_waitcnt lgkmcnt(12)
v_mfma_f32_32x32x16_bf16 v[216:231], v[156:159], v[20:23], v[216:231]
v_cvt_pk_bf16_f32 v170, v172, v173
ds_read_b64_tr_b16 v[152:153], v248 offset:14336
ds_read_b64_tr_b16 v[154:155], v248 offset:15360
s_waitcnt lgkmcnt(12)
v_mfma_f32_32x32x16_bf16 v[200:215], v[128:131], v[32:35], v[200:215]
v_cvt_pk_bf16_f32 v171, v174, v175
ds_read_b64_tr_b16 v[156:157], v249 offset:14336
ds_read_b64_tr_b16 v[158:159], v249 offset:15360
s_waitcnt lgkmcnt(12)
v_mfma_f32_32x32x16_bf16 v[216:231], v[132:135], v[32:35], v[216:231]
s_lshl_b32 s53, s56, 18
s_add_u32 s53, s53, s52
s_add_u32 s56, s56, 1
s_cmp_eq_u32 s56, 7
s_cselect_b32 s56, 0, s56
s_and_b32 s47, s48, 15
s_lshr_b64 s[48:49], s[48:49], 4
s_lshl_b32 s47, s47, 14
v_add_u32 v248, s47, v232
v_add_u32 v249, s47, v233
ds_read_b64_tr_b16 v[128:129], v248 offset:0
ds_read_b64_tr_b16 v[130:131], v248 offset:1024
s_waitcnt lgkmcnt(12)
v_mfma_f32_32x32x16_bf16 v[200:215], v[136:139], v[36:39], v[200:215]
buffer_store_dwordx4 v[168:171], v250, s[40:43], s53 offen  sc1
s_add_u32 s53, s53, 16384
ds_read_b64_tr_b16 v[132:133], v249 offset:0
ds_read_b64_tr_b16 v[134:135], v249 offset:1024
s_waitcnt lgkmcnt(12)
v_mfma_f32_32x32x16_bf16 v[216:231], v[140:143], v[36:39], v[216:231]
v_cvt_pk_bf16_f32 v172, v176, v177
ds_read_b64_tr_b16 v[136:137], v248 offset:2048
ds_read_b64_tr_b16 v[138:139], v248 offset:3072
s_waitcnt lgkmcnt(12)
v_mfma_f32_32x32x16_bf16 v[200:215], v[144:147], v[48:51], v[200:215]
v_cvt_pk_bf16_f32 v173, v178, v179
ds_read_b64_tr_b16 v[140:141], v249 offset:2048
ds_read_b64_tr_b16 v[142:143], v249 offset:3072
s_waitcnt lgkmcnt(12)
v_mfma_f32_32x32x16_bf16 v[216:231], v[148:151], v[48:51], v[216:231]
v_cvt_pk_bf16_f32 v174, v180, v181
ds_read_b64_tr_b16 v[144:145], v248 offset:4096
ds_read_b64_tr_b16 v[146:147], v248 offset:5120
s_waitcnt lgkmcnt(12)
v_mfma_f32_32x32x16_bf16 v[200:215], v[152:155], v[52:55], v[200:215]
v_cvt_pk_bf16_f32 v175, v182, v183
ds_read_b64_tr_b16 v[148:149], v249 offset:4096
ds_read_b64_tr_b16 v[150:151], v249 offset:5120
s_waitcnt lgkmcnt(12)
v_mfma_f32_32x32x16_bf16 v[216:231], v[156:159], v[52:55], v[216:231]
buffer_store_dwordx4 v[172:175], v250, s[40:43], s53 offen  sc1
s_add_u32 s53, s53, 16384
ds_read_b64_tr_b16 v[152:153], v248 offset:6144
ds_read_b64_tr_b16 v[154:155], v248 offset:7168
s_waitcnt lgkmcnt(12)
v_mfma_f32_32x32x16_bf16 v[200:215], v[128:131], v[64:67], v[200:215]
v_cvt_pk_bf16_f32 v184, v184, v185
ds_read_b64_tr_b16 v[156:157], v249 offset:6144
ds_read_b64_tr_b16 v[158:159], v249 offset:7168
s_waitcnt lgkmcnt(12)
v_mfma_f32_32x32x16_bf16 v[216:231], v[132:135], v[64:67], v[216:231]
v_cvt_pk_bf16_f32 v185, v186, v187
ds_read_b64_tr_b16 v[128:129], v248 offset:8192
ds_read_b64_tr_b16 v[130:131], v248 offset:9216
s_waitcnt lgkmcnt(12)
v_mfma_f32_32x32x16_bf16 v[200:215], v[136:139], v[68:71], v[200:215]
v_cvt_pk_bf16_f32 v186, v188, v189
ds_read_b64_tr_b16 v[132:133], v249 offset:8192
ds_read_b64_tr_b16 v[134:135], v249 offset:9216
s_waitcnt lgkmcnt(12)
v_mfma_f32_32x32x16_bf16 v[216:231], v[140:143], v[68:71], v[216:231]
v_cvt_pk_bf16_f32 v187, v190, v191
ds_read_b64_tr_b16 v[136:137], v248 offset:10240
ds_read_b64_tr_b16 v[138:139], v248 offset:11264
s_waitcnt lgkmcnt(12)
v_mfma_f32_32x32x16_bf16 v[200:215], v[144:147], v[80:83], v[200:215]
buffer_store_dwordx4 v[184:187], v250, s[40:43], s53 offen  sc1
s_add_u32 s53, s53, 16384
ds_read_b64_tr_b16 v[140:141], v249 offset:10240
ds_read_b64_tr_b16 v[142:143], v249 offset:11264
s_waitcnt lgkmcnt(12)
v_mfma_f32_32x32x16_bf16 v[216:231], v[148:151], v[80:83], v[216:231]
v_cvt_pk_bf16_f32 v188, v192, v193
ds_read_b64_tr_b16 v[144:145], v248 offset:12288
ds_read_b64_tr_b16 v[146:147], v248 offset:13312
s_waitcnt lgkmcnt(12)
v_mfma_f32_32x32x16_bf16 v[200:215], v[152:155], v[84:87], v[200:215]
v_cvt_pk_bf16_f32 v189, v194, v195
ds_read_b64_tr_b16 v[148:149], v249 offset:12288
ds_read_b64_tr_b16 v[150:151], v249 offset:13312
s_waitcnt lgkmcnt(12)
v_mfma_f32_32x32x16_bf16 v[216:231], v[156:159], v[84:87], v[216:231]
v_cvt_pk_bf16_f32 v190, v196, v197
ds_read_b64_tr_b16 v[152:153], v248 offset:14336
ds_read_b64_tr_b16 v[154:155], v248 offset:15360
s_waitcnt lgkmcnt(12)
v_mfma_f32_32x32x16_bf16 v[200:215], v[128:131], v[96:99], v[200:215]
v_cvt_pk_bf16_f32 v191, v198, v199
ds_read_b64_tr_b16 v[156:157], v249 offset:14336
ds_read_b64_tr_b16 v[158:159], v249 offset:15360
s_waitcnt lgkmcnt(12)
v_mfma_f32_32x32x16_bf16 v[216:231], v[132:135], v[96:99], v[216:231]
buffer_store_dwordx4 v[188:191], v250, s[40:43], s53 offen  sc1
s_add_u32 s53, s53, 16384
s_waitcnt lgkmcnt(10)
v_mfma_f32_32x32x16_bf16 v[200:215], v[136:139], v[100:103], v[200:215]
s_waitcnt vmcnt(4)
buffer_store_dword v252, v237, s[40:43], s57 offen sc1
s_add_u32 s57, s57, 512
s_nop 0
v_mov_b32 v237, v251
s_waitcnt lgkmcnt(8)
v_mfma_f32_32x32x16_bf16 v[216:231], v[140:143], v[100:103], v[216:231]
s_waitcnt lgkmcnt(6)
v_mfma_f32_32x32x16_bf16 v[200:215], v[144:147], v[112:115], v[200:215]
s_waitcnt lgkmcnt(0)
s_barrier
s_and_b32 s47, s48, 15
s_lshr_b64 s[48:49], s[48:49], 4
s_lshl_b32 s47, s47, 14
v_add_u32 v248, s47, v232
v_add_u32 v249, s47, v233
ds_read_b64_tr_b16 v[128:129], v248 offset:0
ds_read_b64_tr_b16 v[130:131], v248 offset:1024
ds_read_b64_tr_b16 v[132:133], v249 offset:0
ds_read_b64_tr_b16 v[134:135], v249 offset:1024
s_waitcnt lgkmcnt(8)
v_mfma_f32_32x32x16_bf16 v[216:231], v[148:151], v[112:115], v[216:231]
ds_read_b64_tr_b16 v[136:137], v248 offset:2048
ds_read_b64_tr_b16 v[138:139], v248 offset:3072
ds_read_b64_tr_b16 v[140:141], v249 offset:2048
ds_read_b64_tr_b16 v[142:143], v249 offset:3072
s_waitcnt lgkmcnt(10)
v_mfma_f32_32x32x16_bf16 v[200:215], v[152:155], v[116:119], v[200:215]
ds_read_b64_tr_b16 v[144:145], v248 offset:4096
ds_read_b64_tr_b16 v[146:147], v248 offset:5120
ds_read_b64_tr_b16 v[148:149], v249 offset:4096
ds_read_b64_tr_b16 v[150:151], v249 offset:5120
s_waitcnt lgkmcnt(12)
v_mfma_f32_32x32x16_bf16 v[216:231], v[156:159], v[116:119], v[216:231]
ds_read_b64_tr_b16 v[152:153], v248 offset:6144
ds_read_b64_tr_b16 v[154:155], v248 offset:7168
s_waitcnt lgkmcnt(12)
v_mfma_f32_32x32x16_bf16 v[168:183], v[128:131], v[0:3], 0
ds_read_b64_tr_b16 v[156:157], v249 offset:6144
ds_read_b64_tr_b16 v[158:159], v249 offset:7168
s_waitcnt lgkmcnt(12)
v_mfma_f32_32x32x16_bf16 v[184:199], v[132:135], v[0:3], 0
ds_read_b64_tr_b16 v[128:129], v248 offset:8192
ds_read_b64_tr_b16 v[130:131], v248 offset:9216
s_waitcnt lgkmcnt(12)
v_mfma_f32_32x32x16_bf16 v[168:183], v[136:139], v[4:7], v[168:183]
ds_read_b64_tr_b16 v[132:133], v249 offset:8192
ds_read_b64_tr_b16 v[134:135], v249 offset:9216
s_waitcnt lgkmcnt(12)
v_mfma_f32_32x32x16_bf16 v[184:199], v[140:143], v[4:7], v[184:199]
ds_read_b64_tr_b16 v[136:137], v248 offset:10240
ds_read_b64_tr_b16 v[138:139], v248 offset:11264
s_waitcnt lgkmcnt(12)
v_mfma_f32_32x32x16_bf16 v[168:183], v[144:147], v[16:19], v[168:183]
ds_read_b64_tr_b16 v[140:141], v249 offset:10240
ds_read_b64_tr_b16 v[142:143], v249 offset:11264
s_waitcnt lgkmcnt(12)
v_mfma_f32_32x32x16_bf16 v[184:199], v[148:151], v[16:19], v[184:199]
v_cvt_pk_bf16_f32 v200, v200, v201
ds_read_b64_tr_b16 v[144:145], v248 offset:12288
ds_read_b64_tr_b16 v[146:147], v248 offset:13312
s_waitcnt lgkmcnt(12)
v_mfma_f32_32x32x16_bf16 v[168:183], v[152:155], v[20:23], v[168:183]
v_cvt_pk_bf16_f32 v201, v202, v203
ds_read_b64_tr_b16 v[148:149], v249 offset:12288
ds_read_b64_tr_b16 v[150:151], v249 offset:13312
s_waitcnt lgkmcnt(12)
v_mfma_f32_32x32x16_bf16 v[184:199], v[156:159], v[20:23], v[184:199]
v_cvt_pk_bf16_f32 v202, v204, v205
ds_read_b64_tr_b16 v[152:153], v248 offset:14336
ds_read_b64_tr_b16 v[154:155], v248 offset:15360
s_waitcnt lgkmcnt(12)
v_mfma_f32_32x32x16_bf16 v[168:183], v[128:131], v[32:35], v[168:183]
v_cvt_pk_bf16_f32 v203, v206, v207
ds_read_b64_tr_b16 v[156:157], v249 offset:14336
ds_read_b64_tr_b16 v[158:159], v249 offset:15360
s_waitcnt lgkmcnt(12)
v_mfma_f32_32x32x16_bf16 v[184:199], v[132:135], v[32:35], v[184:199]
s_lshl_b32 s53, s56, 18
s_add_u32 s53, s53, s52
s_add_u32 s56, s56, 1
s_cmp_eq_u32 s56, 7
s_cselect_b32 s56, 0, s56
s_and_b32 s47, s48, 15
s_lshr_b64 s[48:49], s[48:49], 4
s_lshl_b32 s47, s47, 14
v_add_u32 v248, s47, v232
v_add_u32 v249, s47, v233
ds_read_b64_tr_b16 v[128:129], v248 offset:0
ds_read_b64_tr_b16 v[130:131], v248 offset:1024
s_waitcnt lgkmcnt(12)
v_mfma_f32_32x32x16_bf16 v[168:183], v[136:139], v[36:39], v[168:183]
buffer_store_dwordx4 v[200:203], v250, s[40:43], s53 offen  sc1
s_add_u32 s53, s53, 16384
ds_read_b64_tr_b16 v[132:133], v249 offset:0
ds_read_b64_tr_b16 v[134:135], v249 offset:1024
s_waitcnt lgkmcnt(12)
v_mfma_f32_32x32x16_bf16 v[184:199], v[140:143], v[36:39], v[184:199]
v_cvt_pk_bf16_f32 v204, v208, v209
ds_read_b64_tr_b16 v[136:137], v248 offset:2048
ds_read_b64_tr_b16 v[138:139], v248 offset:3072
s_waitcnt lgkmcnt(12)
v_mfma_f32_32x32x16_bf16 v[168:183], v[144:147], v[48:51], v[168:183]
v_cvt_pk_bf16_f32 v205, v210, v211
ds_read_b64_tr_b16 v[140:141], v249 offset:2048
ds_read_b64_tr_b16 v[142:143], v249 offset:3072
s_waitcnt lgkmcnt(12)
v_mfma_f32_32x32x16_bf16 v[184:199], v[148:151], v[48:51], v[184:199]
v_cvt_pk_bf16_f32 v206, v212, v213
ds_read_b64_tr_b16 v[144:145], v248 offset:4096
ds_read_b64_tr_b16 v[146:147], v248 offset:5120
s_waitcnt lgkmcnt(12)
v_mfma_f32_32x32x16_bf16 v[168:183], v[152:155], v[52:55], v[168:183]
v_cvt_pk_bf16_f32 v207, v214, v215
ds_read_b64_tr_b16 v[148:149], v249 offset:4096
ds_read_b64_tr_b16 v[150:151], v249 offset:5120
s_waitcnt lgkmcnt(12)
v_mfma_f32_32x32x16_bf16 v[184:199], v[156:159], v[52:55], v[184:199]
buffer_store_dwordx4 v[204:207], v250, s[40:43], s53 offen  sc1
s_add_u32 s53, s53, 16384
ds_read_b64_tr_b16 v[152:153], v248 offset:6144
ds_read_b64_tr_b16 v[154:155], v248 offset:7168
s_waitcnt lgkmcnt(12)
v_mfma_f32_32x32x16_bf16 v[168:183], v[128:131], v[64:67], v[168:183]
v_cvt_pk_bf16_f32 v216, v216, v217
ds_read_b64_tr_b16 v[156:157], v249 offset:6144
ds_read_b64_tr_b16 v[158:159], v249 offset:7168
s_waitcnt lgkmcnt(12)
v_mfma_f32_32x32x16_bf16 v[184:199], v[132:135], v[64:67], v[184:199]
v_cvt_pk_bf16_f32 v217, v218, v219
ds_read_b64_tr_b16 v[128:129], v248 offset:8192
ds_read_b64_tr_b16 v[130:131], v248 offset:9216
s_waitcnt lgkmcnt(12)
v_mfma_f32_32x32x16_bf16 v[168:183], v[136:139], v[68:71], v[168:183]
v_cvt_pk_bf16_f32 v218, v220, v221
ds_read_b64_tr_b16 v[132:133], v249 offset:8192
ds_read_b64_tr_b16 v[134:135], v249 offset:9216
s_waitcnt lgkmcnt(12)
v_mfma_f32_32x32x16_bf16 v[184:199], v[140:143], v[68:71], v[184:199]
v_cvt_pk_bf16_f32 v219, v222, v223
ds_read_b64_tr_b16 v[136:137], v248 offset:10240
ds_read_b64_tr_b16 v[138:139], v248 offset:11264
s_waitcnt lgkmcnt(12)
v_mfma_f32_32x32x16_bf16 v[168:183], v[144:147], v[80:83], v[168:183]
buffer_store_dwordx4 v[216:219], v250, s[40:43], s53 offen  sc1
s_add_u32 s53, s53, 16384
ds_read_b64_tr_b16 v[140:141], v249 offset:10240
ds_read_b64_tr_b16 v[142:143], v249 offset:11264
s_waitcnt lgkmcnt(12)
v_mfma_f32_32x32x16_bf16 v[184:199], v[148:151], v[80:83], v[184:199]
v_cvt_pk_bf16_f32 v220, v224, v225
ds_read_b64_tr_b16 v[144:145], v248 offset:12288
ds_read_b64_tr_b16 v[146:147], v248 offset:13312
s_waitcnt lgkmcnt(12)
v_mfma_f32_32x32x16_bf16 v[168:183], v[152:155], v[84:87], v[168:183]
v_cvt_pk_bf16_f32 v221, v226, v227
ds_read_b64_tr_b16 v[148:149], v249 offset:12288
ds_read_b64_tr_b16 v[150:151], v249 offset:13312
s_waitcnt lgkmcnt(12)
v_mfma_f32_32x32x16_bf16 v[184:199], v[156:159], v[84:87], v[184:199]
v_cvt_pk_bf16_f32 v222, v228, v229
ds_read_b64_tr_b16 v[152:153], v248 offset:14336
ds_read_b64_tr_b16 v[154:155], v248 offset:15360
s_waitcnt lgkmcnt(12)
v_mfma_f32_32x32x16_bf16 v[168:183], v[128:131], v[96:99], v[168:183]
v_cvt_pk_bf16_f32 v223, v230, v231
ds_read_b64_tr_b16 v[156:157], v249 offset:14336
ds_read_b64_tr_b16 v[158:159], v249 offset:15360
s_waitcnt lgkmcnt(12)
v_mfma_f32_32x32x16_bf16 v[184:199], v[132:135], v[96:99], v[184:199]
buffer_store_dwordx4 v[220:223], v250, s[40:43], s53 offen  sc1
s_add_u32 s53, s53, 16384
s_waitcnt lgkmcnt(10)
v_mfma_f32_32x32x16_bf16 v[168:183], v[136:139], v[100:103], v[168:183]
s_waitcnt vmcnt(4)
buffer_store_dword v252, v251, s[40:43], s57 offen sc1
s_add_u32 s57, s57, 512
s_waitcnt lgkmcnt(8)
v_mfma_f32_32x32x16_bf16 v[184:199], v[140:143], v[100:103], v[184:199]
s_sub_u32 s50, s50, 1
s_cbranch_scc0 L_loopB
s_waitcnt lgkmcnt(6)
v_mfma_f32_32x32x16_bf16 v[168:183], v[144:147], v[112:115], v[168:183]
s_waitcnt lgkmcnt(4)
v_mfma_f32_32x32x16_bf16 v[184:199], v[148:151], v[112:115], v[184:199]
s_waitcnt lgkmcnt(2)
v_mfma_f32_32x32x16_bf16 v[168:183], v[152:155], v[116:119], v[168:183]
s_waitcnt lgkmcnt(0)
v_mfma_f32_32x32x16_bf16 v[184:199], v[156:159], v[116:119], v[184:199]
s_nop 9
v_cvt_pk_bf16_f32 v168, v168, v169
v_cvt_pk_bf16_f32 v169, v170, v171
v_cvt_pk_bf16_f32 v170, v172, v173
v_cvt_pk_bf16_f32 v171, v174, v175
s_lshl_b32 s53, s56, 18
s_add_u32 s53, s53, s52
s_add_u32 s56, s56, 1
s_cmp_eq_u32 s56, 7
s_cselect_b32 s56, 0, s56
buffer_store_dwordx4 v[168:171], v250, s[40:43], s53 offen  sc1
s_add_u32 s53, s53, 16384
v_cvt_pk_bf16_f32 v172, v176, v177
v_cvt_pk_bf16_f32 v173, v178, v179
v_cvt_pk_bf16_f32 v174, v180, v181
v_cvt_pk_bf16_f32 v175, v182, v183
buffer_store_dwordx4 v[172:175], v250, s[40:43], s53 offen  sc1
s_add_u32 s53, s53, 16384
v_cvt_pk_bf16_f32 v184, v184, v185
v_cvt_pk_bf16_f32 v185, v186, v187
v_cvt_pk_bf16_f32 v186, v188, v189
v_cvt_pk_bf16_f32 v187, v190, v191
buffer_store_dwordx4 v[184:187], v250, s[40:43], s53 offen  sc1
s_add_u32 s53, s53, 16384
v_cvt_pk_bf16_f32 v188, v192, v193
v_cvt_pk_bf16_f32 v189, v194, v195
v_cvt_pk_bf16_f32 v190, v196, v197
v_cvt_pk_bf16_f32 v191, v198, v199
buffer_store_dwordx4 v[188:191], v250, s[40:43], s53 offen  sc1
s_add_u32 s53, s53, 16384
s_waitcnt vmcnt(4)
buffer_store_dword v252, v251, s[40:43], s57 offen sc1
s_add_u32 s57, s57, 512
s_waitcnt vmcnt(1)
buffer_store_dword v252, v251, s[40:43], s57 offen sc1
s_add_u32 s57, s57, 512
s_barrier
L_cend:
v_mbcnt_lo_u32_b32 v0, -1, 0
v_mbcnt_hi_u32_b32 v0, -1, v0
s_lshl_b32 s46, s81, 2
s_add_u32 s46, s46, s44
s_lshl_b32 s47, s46, 7
s_add_u32 s47, s47, 34603008
s_lshl_b32 s46, s46, 2
v_lshlrev_b32 v1, 2, v0
v_and_b32 v2, 3, v0
s_waitcnt vmcnt(0)
buffer_load_dword v254, v1, s[40:43], s47 offen sc1
v_mov_b32 v10, 0
v_cmp_ne_u32 vcc, 0, v253
s_nop 3
s_cmp_eq_u64 vcc, -1
s_cbranch_scc1 L_ht2
buffer_load_ubyte v253, v2, s[88:91], s46 offen sc1
L_ht2:
s_lshr_b32 s82, s6, 2
s_and_b32 s46, s6, 3
s_lshl_b32 s47, s44, 2
s_add_u32 s46, s46, s47
s_lshl_b32 s80, 0x10000, s46
s_and_b32 s80, s80, 0xfffffff
s_mov_b32 s83, 1
s_mov_b32 s59, 1
v_mov_b32 v10, v255
s_branch L_red
L_chk:
s_mov_b32 s59, 0
s_waitcnt vmcnt(0)
v_cmp_eq_u32 vcc, v254, v253
v_cmp_ne_u32 s[46:47], 0, v253
s_nop 3
s_and_b32 s80, vcc_lo, s46
s_and_b32 s80, s80, 0xfffffff
s_mov_b32 s82, s44
s_mov_b32 s83, 0
s_branch L_red
.section .rodata,"a"
.p2align 6
.amdhsa_kernel concat_heads__mha_block_cached__mha_block_cached__near_ridge_kernel
  .amdhsa_next_free_vgpr 256
  .amdhsa_next_free_sgpr 96
  .amdhsa_accum_offset 256
  .amdhsa_group_segment_fixed_size 0
  .amdhsa_kernarg_size 104
  .amdhsa_user_sgpr_count 2
  .amdhsa_user_sgpr_kernarg_segment_ptr 1
  .amdhsa_system_sgpr_workgroup_id_x 1
.end_amdhsa_kernel
```
